```python
import torch

def _softmax(x, axis=-1):
    return torch.softmax(x, dim=axis)

def _gelu(x):
    return torch.nn.functional.gelu(x, approximate='tanh')

def _silu(x):
    return torch.nn.functional.silu(x)

def _sigmoid(x):
    return torch.sigmoid(x)

def _layernorm(x, axis=-1, eps=1e-05):
    m = x.mean(dim=axis, keepdim=True)
    v = x.var(dim=axis, keepdim=True, unbiased=False)
    return (x - m) / torch.sqrt(v + eps)

def _scatter_add(tgt, idx, src, axis=0):
    return tgt.clone().index_add_(axis, idx, src)

def _segment_sum(src, seg, n):
    out = torch.zeros((n,) + src.shape[1:], dtype=src.dtype)
    return out.index_add_(0, seg, src)

def _pad(x, pw):
    flat = tuple((v for pair in reversed(pw) for v in pair))
    return torch.nn.functional.pad(x, flat)
kernel_name = 'adaLN_cond__sliding_block_cached__mixer_channel_mlp__decode'

def setup_inputs():

    _w = lambda a: (lambda t: t.to(torch.bfloat16) if t.is_floating_point() else t)(torch.as_tensor(a))

    def _A_setup():
        B, Sq, D = (2, 1, 576)
        Hq, Hkv, Sk, Dh = (32, 16, 8192, 128)
        assert Hq % Hkv == 0, (Hq, Hkv)
        return {'x': _w((lambda *s: torch.randn(*s, dtype=torch.bfloat16) * 0.1)(B, Sq, D)), 'k_cache': _w((lambda *s: torch.randn(*s, dtype=torch.bfloat16) * 0.8)(B, Hkv, Sk, Dh)), 'v_cache': _w((lambda *s: torch.randn(*s, dtype=torch.bfloat16) * 0.8)(B, Hkv, Sk, Dh)), 'wq': _w((lambda *s: torch.randn(*s, dtype=torch.bfloat16) * 0.8)(D, Hq * Dh) * D ** (-0.5)), 'wo': _w((lambda *s: torch.randn(*s, dtype=torch.bfloat16) * 0.8)(Hq * Dh, D) * (Hq * Dh) ** (-0.5))}
    _A_in = _A_setup()

    def _B_setup():
        B, S, D, F = (2, 1, 576, 4608)
        return {'x': _w((lambda *s: torch.randn(*s, dtype=torch.bfloat16) * 0.1)(B, S, D)), 'w1': _w((lambda *s: torch.randn(*s, dtype=torch.bfloat16) * 3.2)(D, F) * D ** (-0.5)), 'b1': _w((lambda *s: torch.randn(*s, dtype=torch.bfloat16) * 3.2)(F)), 'w2': _w((lambda *s: torch.randn(*s, dtype=torch.bfloat16) * 3.2)(F, D) * F ** (-0.5)), 'b2': _w((lambda *s: torch.randn(*s, dtype=torch.bfloat16) * 3.2)(D))}
    _B_in = _B_setup()
    return {'A_x': _A_in['x'], 'A_k_cache': _A_in['k_cache'], 'A_v_cache': _A_in['v_cache'], 'A_wq': _A_in['wq'], 'A_wo': _A_in['wo'], 'B_x': _B_in['x'], 'B_w1': _B_in['w1'], 'B_b1': _B_in['b1'], 'B_w2': _B_in['w2'], 'B_b2': _B_in['b2'], 'c': _w((lambda *s: torch.randn(*s, dtype=torch.bfloat16) * 0.4)(2, 576) * 8.0), 'w_mod': _w((lambda *s: torch.randn(*s, dtype=torch.bfloat16) * 0.4)(576, 6 * 576) * 576 ** (-0.5) * 8.0)}

def reference(A_x, A_k_cache, A_v_cache, A_wq, A_wo, B_x, B_w1, B_b1, B_w2, B_b2, c, w_mod):

    def _A_ref(x, k_cache, v_cache, wq, wo):
        B, Sq, D = x.shape
        Hq, Dh = (32, 128)
        Hkv, Sk = (k_cache.shape[1], k_cache.shape[2])
        W = min(4096, max(256, Sk // 4))
        rep = Hq // Hkv
        q = (lambda x, *d: x.permute(*d))((x @ wq).reshape(B, Sq, Hq, Dh), 0, 2, 1, 3)
        k = (lambda x, n, axis: torch.repeat_interleave(x, n, dim=axis))(k_cache[:, :, Sk - W:, :], rep, axis=1)
        v = (lambda x, n, axis: torch.repeat_interleave(x, n, dim=axis))(v_cache[:, :, Sk - W:, :], rep, axis=1)
        scores = torch.einsum('bhqd,bhkd->bhqk', q, k) * Dh ** (-0.5)
        p = _softmax(scores, axis=-1)
        o = torch.einsum('bhqk,bhkd->bhqd', p, v)
        return (lambda x, *d: x.permute(*d))(o, 0, 2, 1, 3).reshape(B, Sq, Hq * Dh) @ wo

    def _B_ref(x, w1, b1, w2, b2):
        y = _layernorm(x, axis=-1)
        h = _gelu(torch.einsum('bsd,df->bsf', y, w1) + b1)
        return torch.einsum('bsf,fd->bsd', h, w2) + b2
    x = A_x
    mod = (_silu(c) @ w_mod).reshape(c.shape[0], 6, 1, -1)
    sa, ca, ga, sb, cb, gb = (mod[:, 0].clone(), mod[:, 1].clone(), mod[:, 2].clone(), mod[:, 3].clone(), mod[:, 4].clone(), mod[:, 5].clone())
    h = _layernorm(x, axis=-1) * (1 + ca) + sa
    x = x + ga * _A_ref(h, A_k_cache, A_v_cache, A_wq, A_wo)
    h = _layernorm(x, axis=-1) * (1 + cb) + sb
    x = x + gb * _B_ref(h, B_w1, B_b1, B_w2, B_b2)
    return x
```

```asm
; @launch grid=(256,1,1) block=(1024,1,1) lds=160768
.amdgcn_target "amdgcn-amd-amdhsa--gfx950"
.text
.globl adaLN_cond__sliding_block_cached__mixer_channel_mlp__decode_kernel
.p2align 8
.type adaLN_cond__sliding_block_cached__mixer_channel_mlp__decode_kernel,@function
adaLN_cond__sliding_block_cached__mixer_channel_mlp__decode_kernel:
s_cmp_ge_u32 s2, 256
s_cbranch_scc1 L_exit
s_load_dwordx16 s[16:31], s[0:1], 0
s_load_dwordx8 s[32:39], s[0:1], 64
s_load_dwordx2 s[40:41], s[0:1], 96
s_load_dwordx2 s[42:43], s[0:1], 112
v_lshrrev_b32 v2, 6, v0
v_and_b32 v1, 63, v0
s_and_b32 s4, s2, 7
v_readfirstlane_b32 s3, v2
s_lshr_b32 s5, s2, 3
v_mov_b32 v3, 0
s_cmp_lg_u32 s5, 24
s_cbranch_scc1 L_nopf
s_getpc_b64 s[44:45]
L_pfbase:
s_sub_u32 s44, s44, L_pfbase-adaLN_cond__sliding_block_cached__mixer_channel_mlp__decode_kernel
s_subb_u32 s45, s45, 0
v_lshlrev_b32 v4, 7, v0
v_cmp_gt_u32 vcc, L_codeend-adaLN_cond__sliding_block_cached__mixer_channel_mlp__decode_kernel, v4
s_and_saveexec_b64 s[46:47], vcc
s_cbranch_execz L_pfd
global_load_dword v5, v4, s[44:45]
L_pfd:
s_mov_b64 exec, -1
L_nopf:
s_cmp_lt_u32 s5, 16
s_cbranch_scc1 L_A
s_sub_u32 s5, s5, 16
s_sub_u32 s55, s2, 200
s_min_u32 s47, s4, 4
s_mul_i32 s48, s4, 4
s_add_u32 s47, s47, s48
s_add_u32 s47, s47, s5
s_sub_u32 s47, s47, 9
s_mul_i32 s48, s47, 0xe39
s_lshr_b32 s48, s48, 16
s_mul_i32 s49, s48, 18
s_sub_u32 s49, s47, s49
s_mul_i32 s50, s48, 1990656
s_lshl_b32 s51, s49, 7
s_add_u32 s50, s50, s51
s_lshl_b32 s51, s4, 3
s_add_u32 s51, s51, s5
s_lshl_b32 s52, s51, 7
v_lshrrev_b32 v4, 3, v1
v_bfe_u32 v6, v1, 4, 2
v_lshlrev_b32 v6, 1, v6
v_and_b32 v7, 7, v1
v_xor_b32 v6, v6, v7
s_movk_i32 s53, 6912
s_cmp_lt_u32 s5, 8
s_cselect_b32 s50, s52, s50
s_cselect_b32 s53, 8192, s53
s_cselect_b32 s54, 72, 36
s_mul_i32 s10, s53, 576
s_cselect_b32 s47, s51, s47
s_cselect_b32 s55, 0, s55
v_mul_u32_u24 v14, s53, v4
v_lshl_add_u32 v14, v6, 4, v14
v_add_u32 v15, s50, v14
s_mov_b32 s11, 0x20000
s_lshl_b32 s53, s53, 3
s_mul_i32 s44, s3, s53
s_lshl_b32 s53, s53, 4
s_lshl_b32 s45, s3, 10
s_mov_b32 s46, s3
s_cmp_lt_u32 s5, 8
s_waitcnt lgkmcnt(0)
s_cselect_b32 s8, s22, s38
s_cselect_b32 s9, s23, s39
s_and_b32 s9, s9, 0xffff
s_cmp_ge_u32 s55, 36
s_cbranch_scc1 L_W_nodma
L_W_dma:
s_mov_b32 m0, s45
s_add_u32 s45, s45, 16384
buffer_load_dwordx4 v15, s[8:11], s44 offen nt lds
s_add_u32 s44, s44, s53
s_add_u32 s46, s46, 16
s_cmp_lt_u32 s46, s54
s_cbranch_scc1 L_W_dma
L_W_nodma:
s_load_dword s6, s[42:43], 0
s_branch L_W
L_A:
v_mov_b32 v4, 131072
v_lshl_add_u32 v5, v1, 2, v4
v_bfe_i32 v6, v1, 5, 1
ds_write_b32 v5, v6 offset:512
s_lshr_b32 s44, s5, 3
s_lshl_b32 s45, s4, 1
s_add_u32 s46, s45, s44
s_bfe_u32 s47, s5, 0x10002
s_and_b32 s48, s5, 3
s_lshl_b32 s49, s47, 4
s_add_u32 s49, s49, s46
s_lshl_b32 s49, s49, 21
s_lshl_b32 s50, s48, 15
s_add_u32 s49, s49, s50
s_add_u32 s49, s49, 1572864
s_bfe_u32 s51, s3, 0x10002
s_and_b32 s44, s3, 3
s_lshl_b32 s50, s51, 18
s_add_u32 s49, s49, s50
s_lshl_b32 s50, s44, 13
s_add_u32 s49, s49, s50
s_lshl_b32 s45, s51, 3
s_add_u32 s48, s44, s45
v_and_b32 v9, 3, v1
v_mov_b32 v7, 1
s_cmp_ge_u32 s3, 8
s_cbranch_scc1 L_AV
s_add_u32 s49, s49, 4096
v_bfe_u32 v5, v1, 2, 2
v_lshlrev_b32 v5, 8, v5
v_and_b32 v6, 48, v1
v_lshl_or_b32 v5, v6, 2, v5
v_lshl_or_b32 v5, v9, 4, v5
s_waitcnt lgkmcnt(0)
s_load_dword s6, s[42:43], 0
s_add_u32 s52, s18, s49
s_addc_u32 s53, s19, 0
s_add_u32 s54, s52, 131072
s_addc_u32 s55, s53, 0
global_load_dwordx4 v[32:35], v5, s[52:53] offset:-4096 nt
global_load_dwordx4 v[36:39], v5, s[52:53] offset:-3072 nt
global_load_dwordx4 v[40:43], v5, s[52:53] offset:-2048 nt
global_load_dwordx4 v[44:47], v5, s[52:53] offset:-1024 nt
global_load_dwordx4 v[48:51], v5, s[52:53] offset:0 nt
global_load_dwordx4 v[52:55], v5, s[52:53] offset:1024 nt
global_load_dwordx4 v[56:59], v5, s[52:53] offset:2048 nt
global_load_dwordx4 v[60:63], v5, s[52:53] offset:3072 nt
global_load_dwordx4 v[64:67], v5, s[54:55] offset:-4096 nt
global_load_dwordx4 v[68:71], v5, s[54:55] offset:-3072 nt
global_load_dwordx4 v[72:75], v5, s[54:55] offset:-2048 nt
global_load_dwordx4 v[76:79], v5, s[54:55] offset:-1024 nt
global_load_dwordx4 v[80:83], v5, s[54:55] offset:0 nt
global_load_dwordx4 v[84:87], v5, s[54:55] offset:1024 nt
global_load_dwordx4 v[88:91], v5, s[54:55] offset:2048 nt
global_load_dwordx4 v[92:95], v5, s[54:55] offset:3072 nt
s_barrier
v_bfe_u32 v8, v1, 2, 1
v_lshlrev_b32 v8, 8, v8
v_lshl_or_b32 v8, v6, 2, v8
v_lshl_or_b32 v8, v9, 4, v8
v_add_u32 v8, v4, v8
v_bfe_u32 v11, v1, 4, 1
v_mul_u32_u24 v10, 1152, v11
v_and_b32 v12, 1, v1
v_lshl_add_u32 v10, v12, 4, v10
v_lshrrev_b32 v13, 5, v1
v_lshl_add_u32 v10, v13, 3, v10
v_and_b32 v13, 2, v1
v_lshl_add_u32 v10, v13, 1, v10
v_bfe_u32 v13, v1, 2, 1
v_lshl_add_u32 v10, v13, 1, v10
v_and_b32 v13, 8, v1
v_lshl_add_u32 v10, v13, 3, v10
s_lshr_b32 s44, s48, 1
s_lshl_b32 s44, s44, 7
s_and_b32 s45, s48, 1
s_lshl_b32 s45, s45, 5
s_add_u32 s44, s44, s45
s_add_u32 s44, s44, 132096
v_add_u32 v10, s44, v10
v_lshl_add_u32 v12, v12, 6, v6
v_bfe_u32 v13, v1, 1, 1
v_mul_u32_u24 v13, 1152, v13
v_add3_u32 v12, v12, v13, v4
v_lshl_add_u32 v11, v11, 5, v4
v_and_b32 v13, 31, v1
v_lshl_add_u32 v13, v13, 2, v4
s_lshl_b32 s44, s3, 2
v_add_u32 v11, s44, v11
v_bfe_u32 v17, v1, 4, 1
v_lshl_add_u32 v17, v17, 5, v11
v_and_b32 v18, 32, v1
v_add_u32 v17, v17, v18
v_bfe_u32 v14, v1, 2, 3
v_xor_b32 v14, s3, v14
v_lshlrev_b32 v14, 5, v14
v_lshrrev_b32 v15, 2, v1
v_lshl_or_b32 v14, v15, 8, v14
v_lshl_or_b32 v14, v9, 3, v14
v_add_u32 v15, 98304, v14
v_and_b32 v14, 15, v1
v_lshl_add_u32 v14, v14, 3, v4
s_lshl_b32 s44, s3, 7
v_add_u32 v14, s44, v14
s_mov_b32 s58, 0x22222222
s_mov_b32 s59, 0x22222222
s_mov_b32 s60, 0x44444444
s_mov_b32 s61, 0x44444444
s_mov_b32 s62, 0x88888888
s_mov_b32 s63, 0x88888888
s_lshl_b32 s44, s47, 14
s_lshl_b32 s45, s46, 10
s_add_u32 s44, s44, s45
s_lshl_b32 s45, s3, 7
s_add_u32 s44, s44, s45
s_add_u32 s44, s44, 16384
s_add_u32 s56, s42, s44
s_addc_u32 s57, s43, 0
s_lshl_b32 s50, s4, 4
s_add_u32 s50, s50, s5
s_lshl_b32 s50, s50, 10
s_add_u32 s50, s50, s45
s_add_u32 s50, s50, 1048576
v_lshl_add_u32 v6, v1, 3, s50
s_waitcnt lgkmcnt(0)
s_add_u32 s6, s6, 0x9e3779b9
s_and_b32 s101, s6, 63
s_and_b32 s100, s6, 7
s_waitcnt vmcnt(0)
s_mov_b64 exec, 1
ds_add_u32 v4, v7 offset:524
s_mov_b64 exec, -1
s_mov_b32 s7, 0
LS_1:
s_add_u32 s7, s7, 1
s_cmp_gt_u32 s7, 400000
s_cbranch_scc1 L_end
ds_read_b32 v16, v4 offset:524
s_waitcnt lgkmcnt(0)
v_readfirstlane_b32 s44, v16
s_cmp_ge_u32 s44, 8
s_cbranch_scc1 LD_2
s_sleep 1
s_branch LS_1
LD_2:
s_mov_b32 s7, 0
L_A_qr:
s_add_u32 s7, s7, 1
s_cmp_gt_u32 s7, 400000
s_cbranch_scc1 L_end
s_sleep 2
L_A_qg:
s_load_dwordx16 s[64:79], s[56:57], 0 glc
s_load_dwordx16 s[80:95], s[56:57], 64 glc
L_A_qc:
s_waitcnt lgkmcnt(0)
s_cmp_lg_u32 s65, s6
s_cbranch_scc1 L_A_qr
s_cmp_lg_u32 s67, s6
s_cbranch_scc1 L_A_qr
s_cmp_lg_u32 s69, s6
s_cbranch_scc1 L_A_qr
s_cmp_lg_u32 s71, s6
s_cbranch_scc1 L_A_qr
s_cmp_lg_u32 s73, s6
s_cbranch_scc1 L_A_qr
s_cmp_lg_u32 s75, s6
s_cbranch_scc1 L_A_qr
s_cmp_lg_u32 s77, s6
s_cbranch_scc1 L_A_qr
s_cmp_lg_u32 s79, s6
s_cbranch_scc1 L_A_qr
s_cmp_lg_u32 s81, s6
s_cbranch_scc1 L_A_qr
s_cmp_lg_u32 s83, s6
s_cbranch_scc1 L_A_qr
s_cmp_lg_u32 s85, s6
s_cbranch_scc1 L_A_qr
s_cmp_lg_u32 s87, s6
s_cbranch_scc1 L_A_qr
s_cmp_lg_u32 s89, s6
s_cbranch_scc1 L_A_qr
s_cmp_lg_u32 s91, s6
s_cbranch_scc1 L_A_qr
s_cmp_lg_u32 s93, s6
s_cbranch_scc1 L_A_qr
s_cmp_lg_u32 s95, s6
s_cbranch_scc1 L_A_qr
s_mov_b64 exec, 1
v_mov_b32 v96, s64
v_mov_b32 v97, s66
v_mov_b32 v98, s68
v_mov_b32 v99, s70
v_mov_b32 v100, s72
v_mov_b32 v101, s74
v_mov_b32 v102, s76
v_mov_b32 v103, s78
v_mov_b32 v104, s80
v_mov_b32 v105, s82
v_mov_b32 v106, s84
v_mov_b32 v107, s86
v_mov_b32 v108, s88
v_mov_b32 v109, s90
v_mov_b32 v110, s92
v_mov_b32 v111, s94
s_lshl_b32 s44, s3, 6
v_add_u32 v20, s44, v4
ds_write_b128 v20, v[96:99] offset:0
ds_write_b128 v20, v[100:103] offset:16
ds_write_b128 v20, v[104:107] offset:32
ds_write_b128 v20, v[108:111] offset:48
ds_add_u32 v4, v7 offset:512
s_mov_b64 exec, -1
s_mov_b32 s56, 0xff00ff00
s_mov_b32 s57, 0xff00ff00
s_mov_b32 s7, 0
LS_3:
s_add_u32 s7, s7, 1
s_cmp_gt_u32 s7, 400000
s_cbranch_scc1 L_end
ds_read_b32 v16, v4 offset:512
s_waitcnt lgkmcnt(0)
v_readfirstlane_b32 s44, v16
s_cmp_ge_u32 s44, 8
s_cbranch_scc1 LD_4
s_sleep 1
s_branch LS_3
LD_4:
ds_read_b128 v[20:23], v8 offset:0
s_waitcnt lgkmcnt(0)
v_cndmask_b32 v24, 0, v20, s[56:57]
v_cndmask_b32 v20, v20, 0, s[56:57]
v_cndmask_b32 v25, 0, v21, s[56:57]
v_cndmask_b32 v21, v21, 0, s[56:57]
v_cndmask_b32 v26, 0, v22, s[56:57]
v_cndmask_b32 v22, v22, 0, s[56:57]
v_cndmask_b32 v27, 0, v23, s[56:57]
v_cndmask_b32 v23, v23, 0, s[56:57]
s_waitcnt vmcnt(0)
s_nop 0
v_mfma_f32_16x16x32_bf16 v[96:99], v[20:23], v[32:35], 0
v_mfma_f32_16x16x32_bf16 v[100:103], v[20:23], v[40:43], 0
v_mfma_f32_16x16x32_bf16 v[104:107], v[20:23], v[48:51], 0
v_mfma_f32_16x16x32_bf16 v[108:111], v[20:23], v[56:59], 0
v_mfma_f32_16x16x32_bf16 v[96:99], v[24:27], v[36:39], v[96:99]
v_mfma_f32_16x16x32_bf16 v[100:103], v[24:27], v[44:47], v[100:103]
v_mfma_f32_16x16x32_bf16 v[104:107], v[24:27], v[52:55], v[104:107]
v_mfma_f32_16x16x32_bf16 v[108:111], v[24:27], v[60:63], v[108:111]
v_mfma_f32_16x16x32_bf16 v[32:35], v[20:23], v[64:67], 0
v_mfma_f32_16x16x32_bf16 v[36:39], v[20:23], v[72:75], 0
v_mfma_f32_16x16x32_bf16 v[40:43], v[20:23], v[80:83], 0
v_mfma_f32_16x16x32_bf16 v[44:47], v[20:23], v[88:91], 0
v_mfma_f32_16x16x32_bf16 v[32:35], v[24:27], v[68:71], v[32:35]
v_mov_b32_dpp v112, v96 quad_perm:[0,0,0,0] row_mask:0xf bank_mask:0xf
v_add_f32_dpp v112, v97, v112 quad_perm:[1,1,1,1] row_mask:0xf bank_mask:0xf
v_add_f32_dpp v112, v98, v112 quad_perm:[2,2,2,2] row_mask:0xf bank_mask:0xf
v_add_f32_dpp v112, v99, v112 quad_perm:[3,3,3,3] row_mask:0xf bank_mask:0xf
v_mfma_f32_16x16x32_bf16 v[36:39], v[24:27], v[76:79], v[36:39]
v_mov_b32_dpp v113, v100 quad_perm:[0,0,0,0] row_mask:0xf bank_mask:0xf
v_add_f32_dpp v113, v101, v113 quad_perm:[1,1,1,1] row_mask:0xf bank_mask:0xf
v_add_f32_dpp v113, v102, v113 quad_perm:[2,2,2,2] row_mask:0xf bank_mask:0xf
v_add_f32_dpp v113, v103, v113 quad_perm:[3,3,3,3] row_mask:0xf bank_mask:0xf
v_mfma_f32_16x16x32_bf16 v[40:43], v[24:27], v[84:87], v[40:43]
v_mov_b32_dpp v114, v104 quad_perm:[0,0,0,0] row_mask:0xf bank_mask:0xf
v_add_f32_dpp v114, v105, v114 quad_perm:[1,1,1,1] row_mask:0xf bank_mask:0xf
v_add_f32_dpp v114, v106, v114 quad_perm:[2,2,2,2] row_mask:0xf bank_mask:0xf
v_add_f32_dpp v114, v107, v114 quad_perm:[3,3,3,3] row_mask:0xf bank_mask:0xf
v_mfma_f32_16x16x32_bf16 v[44:47], v[24:27], v[92:95], v[44:47]
v_mov_b32_dpp v115, v108 quad_perm:[0,0,0,0] row_mask:0xf bank_mask:0xf
v_add_f32_dpp v115, v109, v115 quad_perm:[1,1,1,1] row_mask:0xf bank_mask:0xf
v_add_f32_dpp v115, v110, v115 quad_perm:[2,2,2,2] row_mask:0xf bank_mask:0xf
v_add_f32_dpp v115, v111, v115 quad_perm:[3,3,3,3] row_mask:0xf bank_mask:0xf
v_cndmask_b32 v112, v112, v113, s[58:59]
v_cndmask_b32 v112, v112, v114, s[60:61]
v_cndmask_b32 v112, v112, v115, s[62:63]
v_mov_b32_dpp v116, v32 quad_perm:[0,0,0,0] row_mask:0xf bank_mask:0xf
v_add_f32_dpp v116, v33, v116 quad_perm:[1,1,1,1] row_mask:0xf bank_mask:0xf
v_add_f32_dpp v116, v34, v116 quad_perm:[2,2,2,2] row_mask:0xf bank_mask:0xf
v_add_f32_dpp v116, v35, v116 quad_perm:[3,3,3,3] row_mask:0xf bank_mask:0xf
v_mov_b32_dpp v117, v36 quad_perm:[0,0,0,0] row_mask:0xf bank_mask:0xf
v_add_f32_dpp v117, v37, v117 quad_perm:[1,1,1,1] row_mask:0xf bank_mask:0xf
v_add_f32_dpp v117, v38, v117 quad_perm:[2,2,2,2] row_mask:0xf bank_mask:0xf
v_add_f32_dpp v117, v39, v117 quad_perm:[3,3,3,3] row_mask:0xf bank_mask:0xf
v_mov_b32_dpp v118, v40 quad_perm:[0,0,0,0] row_mask:0xf bank_mask:0xf
v_add_f32_dpp v118, v41, v118 quad_perm:[1,1,1,1] row_mask:0xf bank_mask:0xf
v_add_f32_dpp v118, v42, v118 quad_perm:[2,2,2,2] row_mask:0xf bank_mask:0xf
v_add_f32_dpp v118, v43, v118 quad_perm:[3,3,3,3] row_mask:0xf bank_mask:0xf
v_mov_b32_dpp v119, v44 quad_perm:[0,0,0,0] row_mask:0xf bank_mask:0xf
v_add_f32_dpp v119, v45, v119 quad_perm:[1,1,1,1] row_mask:0xf bank_mask:0xf
v_add_f32_dpp v119, v46, v119 quad_perm:[2,2,2,2] row_mask:0xf bank_mask:0xf
v_add_f32_dpp v119, v47, v119 quad_perm:[3,3,3,3] row_mask:0xf bank_mask:0xf
v_cndmask_b32 v116, v116, v117, s[58:59]
v_cndmask_b32 v116, v116, v118, s[60:61]
v_cndmask_b32 v116, v116, v119, s[62:63]
v_cvt_pk_bf16_f32 v112, 0, v112
v_cvt_pk_bf16_f32 v116, 0, v116
v_mul_f32 v112, 0x3db504f3, v112
v_mul_f32 v116, 0x3db504f3, v116
v_cvt_pk_bf16_f32 v112, 0, v112
v_cvt_pk_bf16_f32 v116, 0, v116
v_max_f32 v113, v112, v116
s_nop 1
v_max_f32_dpp v113, v113, v113 quad_perm:[1,0,3,2] row_mask:0xf bank_mask:0xf
s_nop 1
v_max_f32_dpp v113, v113, v113 quad_perm:[2,3,0,1] row_mask:0xf bank_mask:0xf
s_nop 1
v_max_f32_dpp v113, v113, v113 row_half_mirror row_mask:0xf bank_mask:0xf
s_nop 1
v_max_f32_dpp v113, v113, v113 row_mirror row_mask:0xf bank_mask:0xf
s_mov_b32 exec_lo, 0x10001
s_mov_b32 exec_hi, 0x10001
ds_write_b32 v17, v113 offset:640
s_mov_b64 exec, -1
ds_read_b32 v118, v4 offset:540
v_mul_f32 v112, 0x3fb8aa3b, v112
v_mul_f32 v116, 0x3fb8aa3b, v116
s_mov_b32 s45, 0x3fb8aa3b
s_mov_b32 s7, 0
L_A_mx:
s_add_u32 s7, s7, 1
s_cmp_gt_u32 s7, 400000
s_cbranch_scc1 L_end
ds_read_b32 v113, v13 offset:640
s_waitcnt lgkmcnt(0)
v_cmp_eq_u32 vcc, -1, v113
s_cbranch_vccnz L_A_mx
v_readfirstlane_b32 s67, v118
s_nop 1
v_max_f32_dpp v113, v113, v113 quad_perm:[1,0,3,2] row_mask:0xf bank_mask:0xf
s_nop 1
v_max_f32_dpp v113, v113, v113 quad_perm:[2,3,0,1] row_mask:0xf bank_mask:0xf
s_nop 1
v_max_f32_dpp v113, v113, v113 row_half_mirror row_mask:0xf bank_mask:0xf
s_nop 1
v_max_f32_dpp v113, v113, v113 row_mirror row_mask:0xf bank_mask:0xf
v_fma_f32 v112, -v113, s45, v112
v_fma_f32 v116, -v113, s45, v116
v_exp_f32 v112, v112
v_exp_f32 v116, v116
s_nop 0
v_cvt_pk_bf16_f32 v115, v112, v116
ds_write_b16 v10, v115
ds_write_b16_d16_hi v10, v115 offset:256
v_add_f32 v112, v112, v116
s_nop 1
v_add_f32_dpp v112, v112, v112 quad_perm:[1,0,3,2] row_mask:0xf bank_mask:0xf
s_nop 1
v_add_f32_dpp v112, v112, v112 quad_perm:[2,3,0,1] row_mask:0xf bank_mask:0xf
s_nop 1
v_add_f32_dpp v112, v112, v112 row_half_mirror row_mask:0xf bank_mask:0xf
s_nop 1
v_add_f32_dpp v112, v112, v112 row_mirror row_mask:0xf bank_mask:0xf
s_mov_b32 exec_lo, 0x10001
s_mov_b32 exec_hi, 0x10001
ds_write_b32 v17, v112 offset:768
s_mov_b64 exec, 1
ds_add_u32 v4, v7 offset:520
s_mov_b64 exec, -1
v_mov_b32 v20, v113
v_bfe_i32 v19, v1, 0, 1
v_and_b32 v19, 0xaaaa, v19
v_or_b32 v19, 0x4444, v19
v_mov_b32 v112, 0
v_mov_b32 v113, 0
v_mov_b32 v114, 0
v_mov_b32 v115, 0
s_cmp_lt_u32 s67, 4
s_cbranch_scc1 L_A_np
ds_read_b64_tr_b16 v[32:33], v15 offset:0
ds_read_b64_tr_b16 v[34:35], v15 offset:4096
ds_read_b64_tr_b16 v[36:37], v15 offset:8192
ds_read_b64_tr_b16 v[38:39], v15 offset:12288
ds_read_b64_tr_b16 v[40:41], v15 offset:16384
ds_read_b64_tr_b16 v[42:43], v15 offset:20480
ds_read_b64_tr_b16 v[44:45], v15 offset:24576
ds_read_b64_tr_b16 v[46:47], v15 offset:28672
L_A_np:
s_mov_b32 s7, 0
LS_5:
s_add_u32 s7, s7, 1
s_cmp_gt_u32 s7, 400000
s_cbranch_scc1 L_end
ds_read_b32 v16, v4 offset:520
s_waitcnt lgkmcnt(0)
v_readfirstlane_b32 s44, v16
s_cmp_ge_u32 s44, 8
s_cbranch_scc1 LD_6
s_sleep 1
s_branch LS_5
LD_6:
ds_read_b128 v[64:67], v12 offset:1792
ds_read_b128 v[68:71], v12 offset:1920
s_cmp_lg_u32 s3, 0
s_cbranch_scc1 L_A_nml
ds_read_b32 v21, v13 offset:768
s_lshl_b32 s50, s4, 4
s_add_u32 s50, s50, s5
s_lshl_b32 s50, s50, 7
s_add_u32 s50, s50, 1179648
v_mov_b32 v24, s50
v_mov_b32 v22, v20
s_waitcnt lgkmcnt(0)
s_nop 1
v_add_f32_dpp v21, v21, v21 quad_perm:[1,0,3,2] row_mask:0xf bank_mask:0xf
s_nop 1
v_add_f32_dpp v21, v21, v21 quad_perm:[2,3,0,1] row_mask:0xf bank_mask:0xf
s_nop 1
v_add_f32_dpp v21, v21, v21 row_half_mirror row_mask:0xf bank_mask:0xf
s_nop 1
v_add_f32_dpp v21, v21, v21 row_mirror row_mask:0xf bank_mask:0xf
v_mov_b32 v23, v21
v_permlane16_swap_b32 v20, v22
s_nop 0
v_permlane16_swap_b32 v21, v23
v_bfi_b32 v20, 63, s101, v20
v_bfi_b32 v21, 63, s101, v21
v_bfi_b32 v22, 63, s101, v22
v_bfi_b32 v23, 63, s101, v23
s_mov_b64 exec, 1
global_store_dwordx4 v24, v[20:23], s[42:43]
v_add_u32 v24, 524288, v24
global_store_dwordx4 v24, v[20:23], s[42:43] sc1
s_mov_b64 exec, -1
L_A_nml:
s_cmp_lt_u32 s67, 4
s_cbranch_scc1 L_A_slow
s_waitcnt lgkmcnt(1)
v_smfmac_f32_16x16x64_bf16 v[112:115], v[64:67], v[32:39], v19
s_waitcnt lgkmcnt(0)
v_smfmac_f32_16x16x64_bf16 v[112:115], v[68:71], v[40:47], v19
L_A_pd:
s_mov_b32 s7, 0
LS_7:
s_add_u32 s7, s7, 1
s_cmp_gt_u32 s7, 400000
s_cbranch_scc1 L_end
ds_read_b32 v120, v4 offset:544
s_waitcnt lgkmcnt(0)
v_readfirstlane_b32 s44, v120
s_cmp_ge_u32 s44, 4
s_cbranch_scc1 LD_8
s_sleep 1
s_branch LS_7
LD_8:
ds_read_b64 v[118:119], v14 offset:3328
s_waitcnt lgkmcnt(0)
s_branch L_A_fin
L_A_slow:
s_mov_b32 s7, 0
L_A_w:
s_add_u32 s7, s7, 1
s_cmp_gt_u32 s7, 400000
s_cbranch_scc1 L_end
s_sleep 1
ds_read2_b32 v[120:121], v4 offset0:135 offset1:136
s_waitcnt lgkmcnt(0)
v_readfirstlane_b32 s44, v120
v_readfirstlane_b32 s45, v121
s_cmp_ge_u32 s45, 4
s_cbranch_scc1 L_A_y
s_cmp_lt_u32 s44, 4
s_cbranch_scc1 L_A_w
ds_read_b64_tr_b16 v[32:33], v15 offset:0
ds_read_b64_tr_b16 v[34:35], v15 offset:4096
ds_read_b64_tr_b16 v[36:37], v15 offset:8192
ds_read_b64_tr_b16 v[38:39], v15 offset:12288
ds_read_b64_tr_b16 v[40:41], v15 offset:16384
ds_read_b64_tr_b16 v[42:43], v15 offset:20480
ds_read_b64_tr_b16 v[44:45], v15 offset:24576
ds_read_b64_tr_b16 v[46:47], v15 offset:28672
s_waitcnt lgkmcnt(4)
v_smfmac_f32_16x16x64_bf16 v[112:115], v[64:67], v[32:39], v19
s_waitcnt lgkmcnt(0)
v_smfmac_f32_16x16x64_bf16 v[112:115], v[68:71], v[40:47], v19
s_branch L_A_pd
L_A_y:
ds_read_b64 v[118:119], v14 offset:3328
s_cmp_ge_u32 s44, 4
s_cbranch_scc1 L_A_y2
s_mov_b32 s7, 0
LS_9:
s_add_u32 s7, s7, 1
s_cmp_gt_u32 s7, 400000
s_cbranch_scc1 L_end
ds_read_b32 v120, v4 offset:540
s_waitcnt lgkmcnt(0)
v_readfirstlane_b32 s44, v120
s_cmp_ge_u32 s44, 4
s_cbranch_scc1 LD_10
s_sleep 1
s_branch LS_9
LD_10:
L_A_y2:
ds_read_b64_tr_b16 v[32:33], v15 offset:0
ds_read_b64_tr_b16 v[34:35], v15 offset:4096
ds_read_b64_tr_b16 v[36:37], v15 offset:8192
ds_read_b64_tr_b16 v[38:39], v15 offset:12288
ds_read_b64_tr_b16 v[40:41], v15 offset:16384
ds_read_b64_tr_b16 v[42:43], v15 offset:20480
ds_read_b64_tr_b16 v[44:45], v15 offset:24576
ds_read_b64_tr_b16 v[46:47], v15 offset:28672
s_waitcnt lgkmcnt(4)
v_smfmac_f32_16x16x64_bf16 v[112:115], v[64:67], v[32:39], v19
s_waitcnt lgkmcnt(0)
v_smfmac_f32_16x16x64_bf16 v[112:115], v[68:71], v[40:47], v19
s_nop 6
L_A_fin:
s_mov_b64 exec, 0xffff
v_add_f32 v112, v112, v113
v_add_f32 v113, v114, v115
v_add_f32 v112, v112, v118
v_add_f32 v113, v113, v119
v_bfi_b32 v116, 63, s101, v112
v_bfi_b32 v117, 63, s101, v113
global_store_dwordx2 v6, v[116:117], s[42:43]
v_add_u32 v6, 524288, v6
global_store_dwordx2 v6, v[116:117], s[42:43] sc1
s_mov_b64 exec, -1
s_branch L_AX
L_AV:
s_lshl_b32 s45, s48, 13
s_mov_b32 s44, s49
v_lshrrev_b32 v5, 4, v1
v_lshlrev_b32 v6, 1, v5
v_and_b32 v8, 15, v1
v_xor_b32 v6, v6, v8
v_lshlrev_b32 v6, 4, v6
v_lshl_or_b32 v5, v5, 8, v6
v_xor_b32 v6, 128, v5
s_waitcnt lgkmcnt(0)
s_load_dword s6, s[42:43], 0
s_mov_b32 s8, s20
s_and_b32 s9, s21, 0xffff
s_mov_b32 s10, 67108864
s_mov_b32 s11, 0x20000
s_barrier
s_mov_b32 m0, s45
s_nop 0
buffer_load_dwordx4 v5, s[8:11], s44 offen offset:0 nt lds
buffer_load_dwordx4 v6, s[8:11], s44 offen offset:1024 nt lds
buffer_load_dwordx4 v5, s[8:11], s44 offen offset:2048 nt lds
buffer_load_dwordx4 v6, s[8:11], s44 offen offset:3072 nt lds
s_add_u32 s45, s45, 4096
s_add_u32 s44, s44, 4096
s_mov_b32 m0, s45
s_nop 0
buffer_load_dwordx4 v5, s[8:11], s44 offen offset:0 nt lds
buffer_load_dwordx4 v6, s[8:11], s44 offen offset:1024 nt lds
buffer_load_dwordx4 v5, s[8:11], s44 offen offset:2048 nt lds
buffer_load_dwordx4 v6, s[8:11], s44 offen offset:3072 nt lds
s_add_u32 s45, s45, 28672
s_add_u32 s44, s44, 126976
s_mov_b32 m0, s45
s_nop 0
buffer_load_dwordx4 v5, s[8:11], s44 offen offset:0 nt lds
buffer_load_dwordx4 v6, s[8:11], s44 offen offset:1024 nt lds
buffer_load_dwordx4 v5, s[8:11], s44 offen offset:2048 nt lds
buffer_load_dwordx4 v6, s[8:11], s44 offen offset:3072 nt lds
s_add_u32 s45, s45, 4096
s_add_u32 s44, s44, 4096
s_mov_b32 m0, s45
s_nop 0
buffer_load_dwordx4 v5, s[8:11], s44 offen offset:0 nt lds
buffer_load_dwordx4 v6, s[8:11], s44 offen offset:1024 nt lds
buffer_load_dwordx4 v5, s[8:11], s44 offen offset:2048 nt lds
buffer_load_dwordx4 v6, s[8:11], s44 offen offset:3072 nt lds
s_lshl_b32 s44, s51, 3
v_add_u32 v5, s44, v4
s_mov_b64 exec, 1
s_waitcnt vmcnt(8)
ds_add_u32 v5, v7 offset:528
s_waitcnt vmcnt(0)
ds_add_u32 v5, v7 offset:532
s_mov_b64 exec, -1
s_waitcnt lgkmcnt(0)
s_cmp_ge_u32 s3, 12
s_cbranch_scc1 L_AXv
s_and_b32 s45, s3, 3
s_lshl_b32 s45, s45, 1
v_bfe_u32 v5, v1, 2, 3
v_xor_b32 v5, s45, v5
v_lshlrev_b32 v5, 5, v5
v_lshrrev_b32 v6, 2, v1
v_lshl_or_b32 v5, v6, 8, v5
v_lshl_or_b32 v5, v9, 3, v5
v_xor_b32 v6, 32, v5
v_bfe_u32 v3, v1, 1, 1
v_mul_u32_u24 v3, 1152, v3
v_and_b32 v2, 48, v1
v_add3_u32 v3, v3, v2, v4
v_and_b32 v2, 1, v1
v_lshl_add_u32 v3, v2, 6, v3
v_lshl_add_u32 v2, v8, 3, v4
s_lshl_b32 s45, s45, 7
v_add_u32 v2, s45, v2
v_bfe_i32 v126, v1, 0, 1
v_and_b32 v126, 0xaaaa, v126
v_or_b32 v126, 0x4444, v126
v_mov_b32 v8, 0
v_mov_b32 v9, 0
v_mov_b32 v10, 0
v_mov_b32 v11, 0
v_mov_b32 v12, 0
v_mov_b32 v13, 0
v_mov_b32 v14, 0
v_mov_b32 v15, 0
s_mov_b32 s7, 0
LS_11:
s_add_u32 s7, s7, 1
s_cmp_gt_u32 s7, 400000
s_cbranch_scc1 L_end
ds_read_b32 v124, v4 offset:532
s_waitcnt lgkmcnt(0)
v_readfirstlane_b32 s44, v124
s_cmp_ge_u32 s44, 4
s_cbranch_scc1 LD_12
s_sleep 1
s_branch LS_11
LD_12:
ds_read_b64_tr_b16 v[16:17], v5 offset:0
ds_read_b64_tr_b16 v[18:19], v5 offset:4096
ds_read_b64_tr_b16 v[24:25], v6 offset:0
ds_read_b64_tr_b16 v[26:27], v6 offset:4096
ds_read_b64_tr_b16 v[20:21], v5 offset:8192
ds_read_b64_tr_b16 v[22:23], v5 offset:12288
ds_read_b64_tr_b16 v[28:29], v6 offset:8192
ds_read_b64_tr_b16 v[30:31], v6 offset:12288
ds_read_b64_tr_b16 v[32:33], v5 offset:16384
ds_read_b64_tr_b16 v[34:35], v5 offset:20480
ds_read_b64_tr_b16 v[40:41], v6 offset:16384
ds_read_b64_tr_b16 v[42:43], v6 offset:20480
ds_read_b64_tr_b16 v[36:37], v5 offset:24576
ds_read_b64_tr_b16 v[38:39], v5 offset:28672
ds_read_b64_tr_b16 v[44:45], v6 offset:24576
ds_read_b64_tr_b16 v[46:47], v6 offset:28672
ds_read_b64_tr_b16 v[48:49], v5 offset:32768
ds_read_b64_tr_b16 v[50:51], v5 offset:36864
ds_read_b64_tr_b16 v[56:57], v6 offset:32768
ds_read_b64_tr_b16 v[58:59], v6 offset:36864
ds_read_b64_tr_b16 v[52:53], v5 offset:40960
ds_read_b64_tr_b16 v[54:55], v5 offset:45056
ds_read_b64_tr_b16 v[60:61], v6 offset:40960
ds_read_b64_tr_b16 v[62:63], v6 offset:45056
ds_read_b64_tr_b16 v[64:65], v5 offset:49152
ds_read_b64_tr_b16 v[66:67], v5 offset:53248
ds_read_b64_tr_b16 v[72:73], v6 offset:49152
ds_read_b64_tr_b16 v[74:75], v6 offset:53248
ds_read_b64_tr_b16 v[68:69], v5 offset:57344
ds_read_b64_tr_b16 v[70:71], v5 offset:61440
ds_read_b64_tr_b16 v[76:77], v6 offset:57344
ds_read_b64_tr_b16 v[78:79], v6 offset:61440
v_add_u32 v5, 0x10000, v5
v_add_u32 v6, 0x10000, v6
s_mov_b32 s7, 0
L_AV_w:
s_add_u32 s7, s7, 1
s_cmp_gt_u32 s7, 400000
s_cbranch_scc1 L_end
s_sleep 1
ds_read2_b32 v[124:125], v4 offset0:130 offset1:134
s_waitcnt lgkmcnt(0)
v_readfirstlane_b32 s44, v125
v_readfirstlane_b32 s45, v124
s_cmp_ge_u32 s44, 4
s_cbranch_scc1 L_AV_x
s_cmp_lt_u32 s45, 8
s_cbranch_scc1 L_AV_w
ds_read_b128 v[112:115], v3 offset:1024
ds_read_b128 v[116:119], v3 offset:1152
ds_read_b128 v[120:123], v3 offset:1280
s_waitcnt lgkmcnt(2)
v_smfmac_f32_16x16x64_bf16 v[8:11], v[112:115], v[16:23], v126
v_smfmac_f32_16x16x64_bf16 v[12:15], v[112:115], v[24:31], v126
ds_read_b128 v[16:19], v3 offset:1408
s_waitcnt lgkmcnt(2)
v_smfmac_f32_16x16x64_bf16 v[8:11], v[116:119], v[32:39], v126
v_smfmac_f32_16x16x64_bf16 v[12:15], v[116:119], v[40:47], v126
s_waitcnt lgkmcnt(1)
v_smfmac_f32_16x16x64_bf16 v[8:11], v[120:123], v[48:55], v126
v_smfmac_f32_16x16x64_bf16 v[12:15], v[120:123], v[56:63], v126
s_waitcnt lgkmcnt(0)
v_smfmac_f32_16x16x64_bf16 v[8:11], v[16:19], v[64:71], v126
v_smfmac_f32_16x16x64_bf16 v[12:15], v[16:19], v[72:79], v126
s_mov_b32 s7, 0
LS_13:
s_add_u32 s7, s7, 1
s_cmp_gt_u32 s7, 400000
s_cbranch_scc1 L_end
ds_read_b32 v124, v4 offset:536
s_waitcnt lgkmcnt(0)
v_readfirstlane_b32 s44, v124
s_cmp_ge_u32 s44, 4
s_cbranch_scc1 LD_14
s_sleep 1
s_branch LS_13
LD_14:
ds_read_b64_tr_b16 v[80:81], v5 offset:0
ds_read_b64_tr_b16 v[82:83], v5 offset:4096
ds_read_b64_tr_b16 v[88:89], v6 offset:0
ds_read_b64_tr_b16 v[90:91], v6 offset:4096
ds_read_b64_tr_b16 v[84:85], v5 offset:8192
ds_read_b64_tr_b16 v[86:87], v5 offset:12288
ds_read_b64_tr_b16 v[92:93], v6 offset:8192
ds_read_b64_tr_b16 v[94:95], v6 offset:12288
ds_read_b64_tr_b16 v[96:97], v5 offset:16384
ds_read_b64_tr_b16 v[98:99], v5 offset:20480
ds_read_b64_tr_b16 v[104:105], v6 offset:16384
ds_read_b64_tr_b16 v[106:107], v6 offset:20480
ds_read_b64_tr_b16 v[100:101], v5 offset:24576
ds_read_b64_tr_b16 v[102:103], v5 offset:28672
ds_read_b64_tr_b16 v[108:109], v6 offset:24576
ds_read_b64_tr_b16 v[110:111], v6 offset:28672
ds_read_b128 v[112:115], v3 offset:1536
ds_read_b128 v[116:119], v3 offset:1664
s_waitcnt lgkmcnt(1)
v_smfmac_f32_16x16x64_bf16 v[8:11], v[112:115], v[80:87], v126
v_smfmac_f32_16x16x64_bf16 v[12:15], v[112:115], v[88:95], v126
s_waitcnt lgkmcnt(0)
v_smfmac_f32_16x16x64_bf16 v[8:11], v[116:119], v[96:103], v126
v_smfmac_f32_16x16x64_bf16 v[12:15], v[116:119], v[104:111], v126
s_branch L_AV_f
L_AV_x:
ds_read_b64_tr_b16 v[80:81], v5 offset:0
ds_read_b64_tr_b16 v[82:83], v5 offset:4096
ds_read_b64_tr_b16 v[88:89], v6 offset:0
ds_read_b64_tr_b16 v[90:91], v6 offset:4096
ds_read_b64_tr_b16 v[84:85], v5 offset:8192
ds_read_b64_tr_b16 v[86:87], v5 offset:12288
ds_read_b64_tr_b16 v[92:93], v6 offset:8192
ds_read_b64_tr_b16 v[94:95], v6 offset:12288
ds_read_b64_tr_b16 v[96:97], v5 offset:16384
ds_read_b64_tr_b16 v[98:99], v5 offset:20480
ds_read_b64_tr_b16 v[104:105], v6 offset:16384
ds_read_b64_tr_b16 v[106:107], v6 offset:20480
ds_read_b64_tr_b16 v[100:101], v5 offset:24576
ds_read_b64_tr_b16 v[102:103], v5 offset:28672
ds_read_b64_tr_b16 v[108:109], v6 offset:24576
ds_read_b64_tr_b16 v[110:111], v6 offset:28672
s_mov_b32 s7, 0
LS_15:
s_add_u32 s7, s7, 1
s_cmp_gt_u32 s7, 400000
s_cbranch_scc1 L_end
ds_read_b32 v124, v4 offset:520
s_waitcnt lgkmcnt(0)
v_readfirstlane_b32 s44, v124
s_cmp_ge_u32 s44, 8
s_cbranch_scc1 LD_16
s_sleep 1
s_branch LS_15
LD_16:
ds_read_b128 v[112:115], v3 offset:1024
ds_read_b128 v[116:119], v3 offset:1152
ds_read_b128 v[120:123], v3 offset:1280
s_waitcnt lgkmcnt(2)
v_smfmac_f32_16x16x64_bf16 v[8:11], v[112:115], v[16:23], v126
v_smfmac_f32_16x16x64_bf16 v[12:15], v[112:115], v[24:31], v126
ds_read_b128 v[16:19], v3 offset:1408
ds_read_b128 v[20:23], v3 offset:1536
ds_read_b128 v[112:115], v3 offset:1664
s_waitcnt lgkmcnt(4)
v_smfmac_f32_16x16x64_bf16 v[8:11], v[116:119], v[32:39], v126
v_smfmac_f32_16x16x64_bf16 v[12:15], v[116:119], v[40:47], v126
s_waitcnt lgkmcnt(3)
v_smfmac_f32_16x16x64_bf16 v[8:11], v[120:123], v[48:55], v126
v_smfmac_f32_16x16x64_bf16 v[12:15], v[120:123], v[56:63], v126
s_waitcnt lgkmcnt(2)
v_smfmac_f32_16x16x64_bf16 v[8:11], v[16:19], v[64:71], v126
v_smfmac_f32_16x16x64_bf16 v[12:15], v[16:19], v[72:79], v126
s_waitcnt lgkmcnt(1)
v_smfmac_f32_16x16x64_bf16 v[8:11], v[20:23], v[80:87], v126
v_smfmac_f32_16x16x64_bf16 v[12:15], v[20:23], v[88:95], v126
s_waitcnt lgkmcnt(0)
v_smfmac_f32_16x16x64_bf16 v[8:11], v[112:115], v[96:103], v126
v_smfmac_f32_16x16x64_bf16 v[12:15], v[112:115], v[104:111], v126
L_AV_f:
s_mov_b64 exec, 0xffff
s_nop 5
v_add_f32 v8, v8, v9
v_add_f32 v9, v10, v11
v_add_f32 v12, v12, v13
v_add_f32 v13, v14, v15
ds_write_b64 v2, v[8:9] offset:3328
ds_write_b64 v2, v[12:13] offset:3456
s_mov_b64 exec, 1
ds_add_u32 v4, v7 offset:544
s_mov_b64 exec, -1
s_waitcnt lgkmcnt(0)
L_AXv:
s_add_u32 s6, s6, 0x9e3779b9
s_and_b32 s101, s6, 63
s_and_b32 s100, s6, 7
L_AX:
s_cmp_ge_u32 s5, 9
s_cbranch_scc1 L_end
s_lshr_b32 s44, s3, 1
s_mul_i32 s44, s44, 4608
s_and_b32 s45, s3, 1
s_lshl_b32 s45, s45, 8
s_add_u32 s44, s44, s45
s_lshl_b32 s45, s5, 9
s_add_u32 s44, s44, s45
s_add_u32 s44, s44, 131072
s_add_u32 s60, s42, s44
s_addc_u32 s61, s43, 0
s_lshl_b32 s44, s3, 8
s_add_u32 s44, s44, 135680
v_lshl_add_u32 v2, v1, 2, s44
v_mov_b32 v26, 0
v_mov_b32 v27, 0
v_mov_b32 v24, 0
s_cmp_lg_u32 s3, 12
s_cbranch_scc1 L_AX_p
s_lshl_b32 s44, s5, 6
v_add_u32 v16, s44, v1
v_lshlrev_b32 v17, 1, v16
global_load_ushort v80, v17, s[16:17]
global_load_ushort v81, v17, s[16:17] offset:1152
v_lshlrev_b32 v18, 3, v16
v_add_u32 v17, 264448, v18
v_add_u32 v18, 271360, v18
s_mul_i32 s44, s4, 9216
s_add_u32 s45, s44, 1196032
v_lshl_add_u32 v26, v16, 4, s45
s_add_u32 s45, s44, 1269760
v_lshl_add_u32 v27, v16, 4, s45
s_lshl_b32 s44, s4, 11
s_lshl_b32 s45, s5, 4
s_add_u32 s44, s44, s45
s_add_u32 s44, s44, 1343488
v_lshl_add_u32 v24, v1, 4, s44
v_and_b32 v25, 48, v1
v_lshlrev_b32 v25, 3, v25
v_and_b32 v16, 7, v1
v_lshl_or_b32 v25, v16, 4, v25
v_and_b32 v16, 8, v1
v_add3_u32 v25, v25, v16, v4
s_mov_b32 s7, 0
L_AX_mg:
s_add_u32 s7, s7, 1
s_cmp_gt_u32 s7, 400000
s_cbranch_scc1 L_end
global_load_dwordx2 v[40:41], v17, s[42:43] offset:-2304 sc1
global_load_dwordx2 v[34:35], v17, s[42:43] offset:2304 sc1
global_load_dwordx2 v[42:43], v18, s[42:43] offset:0 sc1
s_waitcnt vmcnt(0)
v_min3_u32 v30, v41, v35, s6
v_max3_u32 v31, v41, v35, s6
v_min3_u32 v30, v43, v43, v30
v_max3_u32 v31, v43, v43, v31
v_cmp_ne_u32 vcc, v30, v31
s_cbranch_vccnz L_AX_mg
v_lshlrev_b32 v82, 16, v40
v_and_b32 v83, 0xffff0000, v40
v_and_b32 v43, 0xffff0000, v42
v_lshlrev_b32 v42, 16, v42
v_add_f32 v42, 1.0, v42
v_add_f32 v43, 1.0, v43
v_cvt_pk_bf16_f32 v32, v42, v43
v_mov_b32 v33, s6
global_store_dwordx4 v26, v[32:35], s[42:43]
v_add_u32 v26, 524288, v26
global_store_dwordx4 v26, v[32:35], s[42:43] sc1
v_lshlrev_b32 v80, 16, v80
v_lshlrev_b32 v81, 16, v81
v_lshlrev_b32 v84, 16, v32
v_and_b32 v85, 0xffff0000, v32
v_lshlrev_b32 v86, 16, v34
v_and_b32 v87, 0xffff0000, v34
v_mov_b32 v96, v84
v_mov_b32 v97, v85
v_mul_f32 v98, v84, v84
v_mul_f32 v99, v85, v85
v_mov_b32 v100, v86
v_mov_b32 v101, v87
v_mul_f32 v102, v86, v86
v_mul_f32 v103, v87, v87
v_mul_f32 v104, v84, v86
v_mul_f32 v105, v85, v87
v_mov_b32 v106, 0
v_mov_b32 v107, 0
v_permlane32_swap_b32 v96, v97
v_permlane32_swap_b32 v98, v99
v_permlane32_swap_b32 v100, v101
v_permlane32_swap_b32 v102, v103
v_permlane32_swap_b32 v104, v105
v_permlane32_swap_b32 v106, v107
v_add_f32 v96, v96, v97
v_add_f32 v98, v98, v99
v_add_f32 v100, v100, v101
v_add_f32 v102, v102, v103
v_add_f32 v104, v104, v105
v_add_f32 v106, v106, v107
s_nop 0
v_permlane16_swap_b32 v96, v98
v_permlane16_swap_b32 v100, v102
v_permlane16_swap_b32 v104, v106
v_add_f32 v96, v96, v98
v_add_f32 v100, v100, v102
v_add_f32 v104, v104, v106
v_add_f32_dpp v96, v96, v96 quad_perm:[1,0,3,2] row_mask:0xf bank_mask:0xf
v_add_f32_dpp v100, v100, v100 quad_perm:[1,0,3,2] row_mask:0xf bank_mask:0xf
v_add_f32_dpp v104, v104, v104 quad_perm:[1,0,3,2] row_mask:0xf bank_mask:0xf
v_add_f32_dpp v96, v96, v96 quad_perm:[2,3,0,1] row_mask:0xf bank_mask:0xf
v_add_f32_dpp v100, v100, v100 quad_perm:[2,3,0,1] row_mask:0xf bank_mask:0xf
v_add_f32_dpp v104, v104, v104 quad_perm:[2,3,0,1] row_mask:0xf bank_mask:0xf
v_add_f32_dpp v96, v96, v96 row_half_mirror row_mask:0xf bank_mask:0xf
v_add_f32_dpp v100, v100, v100 row_half_mirror row_mask:0xf bank_mask:0xf
v_add_f32_dpp v104, v104, v104 row_half_mirror row_mask:0xf bank_mask:0xf
v_add_f32_dpp v96, v96, v96 row_mirror row_mask:0xf bank_mask:0xf
v_add_f32_dpp v100, v100, v100 row_mirror row_mask:0xf bank_mask:0xf
v_add_f32_dpp v104, v104, v104 row_mirror row_mask:0xf bank_mask:0xf
s_mov_b32 exec_lo, 0x10001
s_mov_b32 exec_hi, 0x10001
v_bfi_b32 v108, 63, s101, v96
v_bfi_b32 v109, 63, s101, v100
v_bfi_b32 v110, 63, s101, v104
global_store_dwordx3 v24, v[108:110], s[42:43] offset:0
v_add_u32 v111, 524288, v24
global_store_dwordx3 v111, v[108:110], s[42:43] offset:0 sc1
s_mov_b64 exec, -1
L_AX_p:
s_mov_b32 s7, 0
L_AX_q:
s_add_u32 s7, s7, 1
s_cmp_gt_u32 s7, 400000
s_cbranch_scc1 L_end
s_sleep 1
s_load_dwordx16 s[8:23], s[60:61], 0 glc
s_load_dwordx16 s[24:39], s[60:61], 64 glc
s_load_dwordx16 s[44:59], s[60:61], 128 glc
s_load_dwordx16 s[64:79], s[60:61], 192 glc
s_waitcnt lgkmcnt(0)
s_xor_b32 s62, s23, s101
s_xor_b32 s63, s39, s101
s_or_b32 s62, s62, s63
s_xor_b32 s63, s59, s101
s_or_b32 s62, s62, s63
s_xor_b32 s63, s79, s101
s_or_b32 s62, s62, s63
s_and_b32 s62, s62, 63
s_cbranch_scc1 L_AX_q
v_writelane_b32 v3, s8, 0
v_writelane_b32 v3, s9, 1
v_writelane_b32 v3, s10, 2
v_writelane_b32 v3, s11, 3
v_writelane_b32 v3, s12, 4
v_writelane_b32 v3, s13, 5
v_writelane_b32 v3, s14, 6
v_writelane_b32 v3, s15, 7
v_writelane_b32 v3, s16, 8
v_writelane_b32 v3, s17, 9
v_writelane_b32 v3, s18, 10
v_writelane_b32 v3, s19, 11
v_writelane_b32 v3, s20, 12
v_writelane_b32 v3, s21, 13
v_writelane_b32 v3, s22, 14
v_writelane_b32 v3, s23, 15
v_writelane_b32 v3, s24, 16
v_writelane_b32 v3, s25, 17
v_writelane_b32 v3, s26, 18
v_writelane_b32 v3, s27, 19
v_writelane_b32 v3, s28, 20
v_writelane_b32 v3, s29, 21
v_writelane_b32 v3, s30, 22
v_writelane_b32 v3, s31, 23
v_writelane_b32 v3, s32, 24
v_writelane_b32 v3, s33, 25
v_writelane_b32 v3, s34, 26
v_writelane_b32 v3, s35, 27
v_writelane_b32 v3, s36, 28
v_writelane_b32 v3, s37, 29
v_writelane_b32 v3, s38, 30
v_writelane_b32 v3, s39, 31
v_writelane_b32 v3, s44, 32
v_writelane_b32 v3, s45, 33
v_writelane_b32 v3, s46, 34
v_writelane_b32 v3, s47, 35
v_writelane_b32 v3, s48, 36
v_writelane_b32 v3, s49, 37
v_writelane_b32 v3, s50, 38
v_writelane_b32 v3, s51, 39
v_writelane_b32 v3, s52, 40
v_writelane_b32 v3, s53, 41
v_writelane_b32 v3, s54, 42
v_writelane_b32 v3, s55, 43
v_writelane_b32 v3, s56, 44
v_writelane_b32 v3, s57, 45
v_writelane_b32 v3, s58, 46
v_writelane_b32 v3, s59, 47
v_writelane_b32 v3, s64, 48
v_writelane_b32 v3, s65, 49
v_writelane_b32 v3, s66, 50
v_writelane_b32 v3, s67, 51
v_writelane_b32 v3, s68, 52
v_writelane_b32 v3, s69, 53
v_writelane_b32 v3, s70, 54
v_writelane_b32 v3, s71, 55
v_writelane_b32 v3, s72, 56
v_writelane_b32 v3, s73, 57
v_writelane_b32 v3, s74, 58
v_writelane_b32 v3, s75, 59
v_writelane_b32 v3, s76, 60
v_writelane_b32 v3, s77, 61
v_writelane_b32 v3, s78, 62
v_writelane_b32 v3, s79, 63
v_xor_b32 v3, s101, v3
v_and_b32 v5, 63, v3
v_cmp_ne_u32 vcc, 0, v5
s_cbranch_vccnz L_AX_q
ds_write_b32 v2, v3
s_waitcnt lgkmcnt(0)
s_barrier
s_cmp_lg_u32 s3, 12
s_cbranch_scc1 L_end
ds_read_b64 v[96:97], v25 offset:4608
ds_read_b64 v[104:105], v25 offset:6656
ds_read_b64 v[98:99], v25 offset:5120
ds_read_b64 v[106:107], v25 offset:7168
ds_read_b64 v[100:101], v25 offset:5632
ds_read_b64 v[108:109], v25 offset:7680
ds_read_b64 v[102:103], v25 offset:6144
ds_read_b64 v[110:111], v25 offset:8192
s_waitcnt lgkmcnt(6)
v_pk_add_f32 v[96:97], v[96:97], v[104:105]
s_waitcnt lgkmcnt(4)
v_pk_add_f32 v[98:99], v[98:99], v[106:107]
s_waitcnt lgkmcnt(2)
v_pk_add_f32 v[100:101], v[100:101], v[108:109]
s_waitcnt lgkmcnt(0)
v_pk_add_f32 v[102:103], v[102:103], v[110:111]
v_pk_add_f32 v[96:97], v[96:97], v[100:101]
v_pk_add_f32 v[98:99], v[98:99], v[102:103]
v_pk_add_f32 v[96:97], v[96:97], v[98:99]
v_cvt_pk_bf16_f32 v96, 0, v96
v_cvt_pk_bf16_f32 v97, 0, v97
v_pk_mul_f32 v[96:97], v[82:83], v[96:97]
v_cvt_pk_bf16_f32 v96, 0, v96
v_cvt_pk_bf16_f32 v97, 0, v97
v_pk_add_f32 v[98:99], v[80:81], v[96:97]
v_cvt_pk_bf16_f32 v96, 0, v98
v_cvt_pk_bf16_f32 v97, 0, v99
v_cvt_pk_bf16_f32 v34, v98, v99
v_pk_mul_f32 v[102:103], v[96:97], v[84:85]
v_cvt_pk_bf16_f32 v32, v102, v103
global_store_dwordx4 v27, v[32:35], s[42:43]
v_cvt_pk_bf16_f32 v100, 0, v102
v_cvt_pk_bf16_f32 v101, 0, v103
v_pk_mul_f32 v[98:99], v[96:97], v[96:97]
v_pk_mul_f32 v[102:103], v[100:101], v[100:101]
v_pk_mul_f32 v[104:105], v[100:101], v[84:85]
v_pk_mul_f32 v[106:107], v[100:101], v[86:87]
v_permlane32_swap_b32 v96, v97
v_permlane32_swap_b32 v98, v99
v_permlane32_swap_b32 v100, v101
v_permlane32_swap_b32 v102, v103
v_permlane32_swap_b32 v104, v105
v_permlane32_swap_b32 v106, v107
v_add_f32 v96, v96, v97
v_add_f32 v98, v98, v99
v_add_f32 v100, v100, v101
v_add_f32 v102, v102, v103
v_add_f32 v104, v104, v105
v_add_f32 v106, v106, v107
s_nop 0
v_permlane16_swap_b32 v96, v98
v_permlane16_swap_b32 v100, v102
v_permlane16_swap_b32 v104, v106
v_add_f32 v96, v96, v98
v_add_f32 v100, v100, v102
v_add_f32 v104, v104, v106
v_add_f32_dpp v96, v96, v96 quad_perm:[1,0,3,2] row_mask:0xf bank_mask:0xf
v_add_f32_dpp v100, v100, v100 quad_perm:[1,0,3,2] row_mask:0xf bank_mask:0xf
v_add_f32_dpp v104, v104, v104 quad_perm:[1,0,3,2] row_mask:0xf bank_mask:0xf
v_add_f32_dpp v96, v96, v96 quad_perm:[2,3,0,1] row_mask:0xf bank_mask:0xf
v_add_f32_dpp v100, v100, v100 quad_perm:[2,3,0,1] row_mask:0xf bank_mask:0xf
v_add_f32_dpp v104, v104, v104 quad_perm:[2,3,0,1] row_mask:0xf bank_mask:0xf
v_add_f32_dpp v96, v96, v96 row_half_mirror row_mask:0xf bank_mask:0xf
v_add_f32_dpp v100, v100, v100 row_half_mirror row_mask:0xf bank_mask:0xf
v_add_f32_dpp v104, v104, v104 row_half_mirror row_mask:0xf bank_mask:0xf
v_add_f32_dpp v96, v96, v96 row_mirror row_mask:0xf bank_mask:0xf
v_add_f32_dpp v100, v100, v100 row_mirror row_mask:0xf bank_mask:0xf
v_add_f32_dpp v104, v104, v104 row_mirror row_mask:0xf bank_mask:0xf
s_mov_b32 exec_lo, 0x10001
s_mov_b32 exec_hi, 0x10001
v_bfi_b32 v108, 63, s101, v96
v_bfi_b32 v109, 63, s101, v100
v_bfi_b32 v110, 63, s101, v104
global_store_dwordx3 v24, v[108:110], s[42:43] offset:1024
v_add_u32 v111, 524288, v24
global_store_dwordx3 v111, v[108:110], s[42:43] offset:1024 sc1
s_mov_b64 exec, -1
v_add_u32 v27, 524288, v27
global_store_dwordx4 v27, v[32:35], s[42:43] sc1
s_branch L_end
L_W:
v_mov_b32 v18, 157248
ds_write2_b32 v18, v3, v3 offset1:1
ds_write_b32 v18, v3 offset:8
v_lshrrev_b32 v8, 5, v0
v_lshlrev_b32 v8, 6, v8
v_bfe_u32 v9, v0, 2, 2
v_lshl_or_b32 v8, v9, 4, v8
v_bfe_u32 v9, v0, 4, 1
v_lshl_or_b32 v8, v9, 3, v8
v_and_b32 v9, 3, v0
v_lshl_or_b32 v8, v9, 1, v8
v_add_u32 v8, 147456, v8
v_lshrrev_b32 v2, 6, v0
v_lshlrev_b32 v2, 7, v2
v_and_b32 v10, 32, v0
v_or_b32 v2, v2, v10
v_and_b32 v10, 13, v0
v_lshl_or_b32 v2, v10, 1, v2
v_bfe_u32 v10, v0, 1, 1
v_lshl_or_b32 v2, v10, 6, v2
v_bfe_u32 v10, v0, 4, 1
v_lshl_or_b32 v2, v10, 2, v2
v_add_u32 v2, 147456, v2
s_and_b32 s46, s3, 3
v_bfe_u32 v10, v1, 3, 2
v_xor_b32 v10, s46, v10
v_lshlrev_b32 v10, 5, v10
v_lshrrev_b32 v11, 2, v1
v_lshl_or_b32 v10, v11, 7, v10
v_lshl_or_b32 v10, v9, 3, v10
v_and_b32 v11, 48, v1
v_add_u32 v11, 147456, v11
v_and_b32 v13, 1, v1
v_mul_u32_u24 v12, 4736, v13
v_add_u32 v12, v11, v12
v_lshl_add_u32 v11, v13, 6, v11
v_and_b32 v13, 4, v1
v_mul_u32_u24 v13, 1184, v13
v_add_u32 v13, v11, v13
v_mov_b32 v17, 1
s_cmp_eq_u32 s5, 8
s_cbranch_scc1 L_KT
s_cmp_gt_u32 s5, 8
s_cbranch_scc1 L_M
s_waitcnt lgkmcnt(0)
s_add_u32 s6, s6, 0x9e3779b9
s_and_b32 s101, s6, 63
s_and_b32 s100, s6, 7
s_barrier
s_cmp_ge_u32 s3, 9
s_cbranch_scc1 L_B_nh
s_mul_i32 s44, s4, 4608
s_add_u32 s44, s44, 1384448
v_lshl_add_u32 v15, v0, 3, s44
global_load_dwordx2 v[24:25], v15, s[42:43] sc1
s_waitcnt vmcnt(0)
s_mov_b64 exec, 1
ds_add_u32 v18, v17 offset:0
s_mov_b64 exec, -1
s_mov_b32 s7, 0
s_branch L_B_chk
L_B_h:
s_add_u32 s7, s7, 1
s_cmp_gt_u32 s7, 400000
s_cbranch_scc1 L_end
s_cmp_lg_u32 s7, 300
s_cbranch_scc1 L_B_h_k
v_add_u32 v15, 524288, v15
L_B_h_k:
s_sleep 2
global_load_dwordx2 v[24:25], v15, s[42:43] sc1
s_waitcnt vmcnt(0)
L_B_chk:
v_cmp_ne_u32 vcc, s6, v25
s_cbranch_vccnz L_B_h
ds_write_b16 v2, v24
ds_write_b16_d16_hi v2, v24 offset:4736
s_waitcnt lgkmcnt(0)
s_barrier
s_branch L_S5
L_B_nh:
s_waitcnt vmcnt(0)
s_mov_b64 exec, 1
ds_add_u32 v18, v17 offset:0
s_mov_b64 exec, -1
s_cmp_ge_u32 s3, 12
s_cbranch_scc1 L_B_m
s_waitcnt lgkmcnt(0)
s_barrier
s_branch L_S5
L_B_m:
s_mov_b32 s7, 0
LS_17:
s_add_u32 s7, s7, 1
s_cmp_gt_u32 s7, 400000
s_cbranch_scc1 L_end
ds_read_b32 v16, v18 offset:0
s_waitcnt lgkmcnt(0)
v_readfirstlane_b32 s44, v16
s_cmp_ge_u32 s44, 16
s_cbranch_scc1 LD_18
s_sleep 1
s_branch LS_17
LD_18:
v_mov_b32 v15, v10
ds_read_b64_tr_b16 v[52:53], v15 offset:0
ds_read_b64_tr_b16 v[54:55], v15 offset:2048
ds_read_b64_tr_b16 v[56:57], v15 offset:4096
ds_read_b64_tr_b16 v[58:59], v15 offset:6144
ds_read_b64_tr_b16 v[60:61], v15 offset:8192
ds_read_b64_tr_b16 v[62:63], v15 offset:10240
ds_read_b64_tr_b16 v[64:65], v15 offset:12288
ds_read_b64_tr_b16 v[66:67], v15 offset:14336
ds_read_b64_tr_b16 v[68:69], v15 offset:16384
ds_read_b64_tr_b16 v[70:71], v15 offset:18432
ds_read_b64_tr_b16 v[72:73], v15 offset:20480
ds_read_b64_tr_b16 v[74:75], v15 offset:22528
ds_read_b64_tr_b16 v[76:77], v15 offset:24576
ds_read_b64_tr_b16 v[78:79], v15 offset:26624
ds_read_b64_tr_b16 v[80:81], v15 offset:28672
ds_read_b64_tr_b16 v[82:83], v15 offset:30720
ds_read_b64_tr_b16 v[84:85], v15 offset:32768
ds_read_b64_tr_b16 v[86:87], v15 offset:34816
ds_read_b64_tr_b16 v[88:89], v15 offset:36864
ds_read_b64_tr_b16 v[90:91], v15 offset:38912
ds_read_b64_tr_b16 v[92:93], v15 offset:40960
ds_read_b64_tr_b16 v[94:95], v15 offset:43008
ds_read_b64_tr_b16 v[96:97], v15 offset:45056
ds_read_b64_tr_b16 v[98:99], v15 offset:47104
ds_read_b64_tr_b16 v[100:101], v15 offset:49152
ds_read_b64_tr_b16 v[102:103], v15 offset:51200
ds_read_b64_tr_b16 v[104:105], v15 offset:53248
ds_read_b64_tr_b16 v[106:107], v15 offset:55296
ds_read_b64_tr_b16 v[108:109], v15 offset:57344
ds_read_b64_tr_b16 v[110:111], v15 offset:59392
ds_read_b64_tr_b16 v[112:113], v15 offset:61440
ds_read_b64_tr_b16 v[114:115], v15 offset:63488
v_add_u32 v15, 65536, v15
ds_read_b64_tr_b16 v[116:117], v15 offset:0
ds_read_b64_tr_b16 v[118:119], v15 offset:2048
ds_read_b64_tr_b16 v[120:121], v15 offset:4096
ds_read_b64_tr_b16 v[122:123], v15 offset:6144
s_lshl_b32 s44, s47, 8
s_lshl_b32 s45, s46, 6
s_add_u32 s44, s44, s45
s_add_u32 s44, s44, 16384
v_and_b32 v15, 15, v1
v_lshlrev_b32 v15, 2, v15
v_bfe_u32 v16, v1, 4, 1
v_lshl_or_b32 v15, v16, 14, v15
v_add_u32 v15, s44, v15
v_bfe_i32 v19, v1, 0, 1
v_and_b32 v19, 0xaaaa, v19
v_or_b32 v19, 0x4444, v19
v_mov_b32 v20, 0
v_mov_b32 v21, 0
v_mov_b32 v22, 0
v_mov_b32 v23, 0
s_waitcnt lgkmcnt(0)
s_barrier
ds_read_b128 v[24:27], v13 offset:0
ds_read_b128 v[28:31], v13 offset:128
ds_read_b128 v[32:35], v13 offset:256
ds_read_b128 v[36:39], v13 offset:384
ds_read_b128 v[40:43], v13 offset:512
ds_read_b128 v[44:47], v13 offset:640
ds_read_b128 v[48:51], v13 offset:768
s_waitcnt lgkmcnt(6)
v_smfmac_f32_16x16x64_bf16 v[20:23], v[24:27], v[52:59], v19
ds_read_b128 v[24:27], v13 offset:896
s_waitcnt lgkmcnt(6)
v_smfmac_f32_16x16x64_bf16 v[20:23], v[28:31], v[60:67], v19
ds_read_b128 v[28:31], v13 offset:1024
s_waitcnt lgkmcnt(6)
v_smfmac_f32_16x16x64_bf16 v[20:23], v[32:35], v[68:75], v19
s_waitcnt lgkmcnt(5)
v_smfmac_f32_16x16x64_bf16 v[20:23], v[36:39], v[76:83], v19
s_waitcnt lgkmcnt(4)
v_smfmac_f32_16x16x64_bf16 v[20:23], v[40:43], v[84:91], v19
s_waitcnt lgkmcnt(3)
v_smfmac_f32_16x16x64_bf16 v[20:23], v[44:47], v[92:99], v19
s_waitcnt lgkmcnt(2)
v_smfmac_f32_16x16x64_bf16 v[20:23], v[48:51], v[100:107], v19
s_waitcnt lgkmcnt(1)
v_smfmac_f32_16x16x64_bf16 v[20:23], v[24:27], v[108:115], v19
s_waitcnt lgkmcnt(0)
v_smfmac_f32_16x16x64_bf16 v[20:23], v[28:31], v[116:123], v19
s_nop 7
v_add_f32 v20, v20, v21
s_nop 1
v_mov_b32_dpp v21, v20 quad_perm:[1,1,3,3] row_mask:0xf bank_mask:0xf
v_mov_b32_dpp v20, v20 quad_perm:[0,0,2,2] row_mask:0xf bank_mask:0xf
v_mov_b32 v23, s6
v_cvt_pk_bf16_f32 v22, v20, v21
s_mov_b32 exec_lo, 0x55555555
s_mov_b32 exec_hi, 0
global_store_dwordx2 v15, v[22:23], s[42:43] sc1
s_mov_b64 exec, -1
s_branch L_S5
L_M:
s_cmp_ge_u32 s3, 9
s_cbranch_scc1 L_M_c
v_lshlrev_b32 v15, 1, v0
global_load_ushort v36, v15, s[36:37]
global_load_ushort v37, v15, s[36:37] offset:1152
L_M_c:
s_cmp_lt_u32 s55, 36
s_cbranch_scc1 L_M_a
s_waitcnt lgkmcnt(0)
s_add_u32 s6, s6, 0x9e3779b9
s_and_b32 s101, s6, 63
s_and_b32 s100, s6, 7
s_branch L_M_bar1
L_M_a:
s_cmp_ge_u32 s3, 9
s_cbranch_scc1 L_M_bar0
s_waitcnt vmcnt(0)
v_lshlrev_b32 v36, 16, v36
v_lshlrev_b32 v37, 16, v37
v_mul_f32 v34, 0xbfb8aa3b, v36
v_mul_f32 v35, 0xbfb8aa3b, v37
v_exp_f32 v34, v34
v_exp_f32 v35, v35
s_nop 0
v_add_f32 v34, 1.0, v34
v_add_f32 v35, 1.0, v35
v_min_f32 v34, 0x7f000000, v34
v_min_f32 v35, 0x7f000000, v35
v_rcp_f32 v38, v34
v_rcp_f32 v39, v35
s_nop 0
v_mul_f32 v40, v36, v38
v_mul_f32 v41, v37, v39
v_fma_f32 v36, -v40, v34, v36
v_fma_f32 v37, -v41, v35, v37
v_fmac_f32 v40, v36, v38
v_fmac_f32 v41, v37, v39
v_cvt_pk_bf16_f32 v36, v40, v41
ds_write_b16 v8, v36
ds_write_b16_d16_hi v8, v36 offset:4736
L_M_bar0:
s_mul_i32 s44, s48, 576
v_add_u32 v15, s44, v12
s_mul_i32 s44, s48, 9216
s_lshl_b32 s45, s49, 9
s_add_u32 s44, s44, s45
s_lshl_b32 s45, s46, 7
s_add_u32 s44, s44, s45
s_add_u32 s44, s44, 196608
v_lshl_add_u32 v18, v1, 4, s44
s_waitcnt vmcnt(0) lgkmcnt(0)
s_add_u32 s6, s6, 0x9e3779b9
s_and_b32 s101, s6, 63
s_and_b32 s100, s6, 7
s_barrier
s_cmp_lt_u32 s3, 12
s_cbranch_scc1 L_M_bar1
ds_read_b64_tr_b16 v[52:53], v10 offset:0
ds_read_b64_tr_b16 v[54:55], v10 offset:2048
ds_read_b64_tr_b16 v[56:57], v10 offset:4096
ds_read_b64_tr_b16 v[58:59], v10 offset:6144
ds_read_b64_tr_b16 v[60:61], v10 offset:8192
ds_read_b64_tr_b16 v[62:63], v10 offset:10240
ds_read_b64_tr_b16 v[64:65], v10 offset:12288
ds_read_b64_tr_b16 v[66:67], v10 offset:14336
ds_read_b64_tr_b16 v[68:69], v10 offset:16384
ds_read_b64_tr_b16 v[70:71], v10 offset:18432
ds_read_b64_tr_b16 v[72:73], v10 offset:20480
ds_read_b64_tr_b16 v[74:75], v10 offset:22528
ds_read_b64_tr_b16 v[76:77], v10 offset:24576
ds_read_b64_tr_b16 v[78:79], v10 offset:26624
ds_read_b64_tr_b16 v[80:81], v10 offset:28672
ds_read_b64_tr_b16 v[82:83], v10 offset:30720
ds_read_b64_tr_b16 v[84:85], v10 offset:32768
ds_read_b64_tr_b16 v[86:87], v10 offset:34816
ds_read_b128 v[24:27], v15 offset:0
ds_read_b128 v[28:31], v15 offset:64
ds_read_b128 v[32:35], v15 offset:128
ds_read_b128 v[36:39], v15 offset:192
ds_read_b128 v[40:43], v15 offset:256
ds_read_b128 v[44:47], v15 offset:320
ds_read_b128 v[48:51], v15 offset:384
s_waitcnt lgkmcnt(6)
v_mfma_f32_16x16x32_bf16 v[20:23], v[24:27], v[52:55], 0
ds_read_b128 v[24:27], v15 offset:448
s_waitcnt lgkmcnt(6)
v_mfma_f32_16x16x32_bf16 v[20:23], v[28:31], v[56:59], v[20:23]
ds_read_b128 v[28:31], v15 offset:512
s_waitcnt lgkmcnt(6)
v_mfma_f32_16x16x32_bf16 v[20:23], v[32:35], v[60:63], v[20:23]
s_waitcnt lgkmcnt(5)
v_mfma_f32_16x16x32_bf16 v[20:23], v[36:39], v[64:67], v[20:23]
s_waitcnt lgkmcnt(4)
v_mfma_f32_16x16x32_bf16 v[20:23], v[40:43], v[68:71], v[20:23]
s_waitcnt lgkmcnt(3)
v_mfma_f32_16x16x32_bf16 v[20:23], v[44:47], v[72:75], v[20:23]
s_waitcnt lgkmcnt(2)
v_mfma_f32_16x16x32_bf16 v[20:23], v[48:51], v[76:79], v[20:23]
s_waitcnt lgkmcnt(1)
v_mfma_f32_16x16x32_bf16 v[20:23], v[24:27], v[80:83], v[20:23]
s_waitcnt lgkmcnt(0)
v_mfma_f32_16x16x32_bf16 v[20:23], v[28:31], v[84:87], v[20:23]
s_mov_b64 exec, 0xffff
s_nop 6
v_add_u32 v20, 4, v20
v_add_u32 v21, 4, v21
v_bfi_b32 v22, 7, s101, v20
v_bfi_b32 v23, 7, s101, v21
s_nop 0
v_mov_b32_dpp v24, v22 row_ror:8 row_mask:0xf bank_mask:0xf
v_mov_b32_dpp v25, v23 row_ror:8 row_mask:0xf bank_mask:0xf
s_mov_b64 exec, 0xff
global_store_dwordx4 v18, v[22:25], s[42:43] sc1
s_mov_b64 exec, -1
L_M_bar1:
s_sub_u32 s44, s5, 9
s_lshl_b32 s50, s44, 1
s_add_u32 s51, s50, 1
s_add_u32 s45, s4, 44
s_cmp_ge_u32 s4, 4
s_cselect_b32 s45, s45, 255
s_cmp_eq_u32 s5, 13
s_cselect_b32 s51, s45, s51
s_lshl_b32 s44, s4, 1
s_add_u32 s44, s44, s5
s_lshl_b32 s44, s44, 1
s_sub_u32 s44, s44, 12
s_add_u32 s45, s44, 1
s_cmp_ge_u32 s5, 14
s_cselect_b32 s50, s44, s50
s_cselect_b32 s51, s45, s51
v_mul_u32_u24 v19, 1152, v4
v_lshl_add_u32 v19, v6, 4, v19
s_mul_i32 s44, s4, 589824
v_add_u32 v19, s44, v19
s_mov_b32 s12, s24
s_and_b32 s13, s25, 0xffff
s_mov_b32 s14, 4718592
s_mov_b32 s15, 0x20000
s_barrier
s_cmp_ge_u32 s3, 3
s_cbranch_scc1 L_M_pt
s_cmp_lg_u32 s5, 13
s_cbranch_scc1 L_M_pt
s_lshl_b32 s44, s4, 14
s_lshl_b32 s45, s3, 13
s_add_u32 s44, s44, s45
s_add_u32 s44, s44, 1048576
s_lshl_b32 s45, s4, 11
s_add_u32 s45, s45, 1179648
s_cmp_eq_u32 s3, 2
s_cselect_b32 s44, s45, s44
s_cselect_b32 s45, 15, 63
v_and_b32 v16, s45, v1
v_lshl_add_u32 v16, v16, 7, s44
global_load_dword v20, v16, s[42:43] sc1
L_M_pt:
s_lshl_b32 s52, s50, 7
s_cmp_ge_u32 s50, 16
s_cbranch_scc1 L_sl0_m
v_add_u32 v16, s52, v19
s_mul_i32 s44, s3, 9216
s_lshl_b32 s45, s3, 10
s_add_u32 s45, s45, 0
s_mov_b32 m0, s45
s_add_u32 s45, s45, 16384
buffer_load_dwordx4 v16, s[12:15], s44 offen nt lds
s_add_u32 s44, s44, 147456
s_mov_b32 m0, s45
s_add_u32 s45, s45, 16384
buffer_load_dwordx4 v16, s[12:15], s44 offen nt lds
s_add_u32 s44, s44, 147456
s_mov_b32 m0, s45
s_add_u32 s45, s45, 16384
buffer_load_dwordx4 v16, s[12:15], s44 offen nt lds
s_add_u32 s44, s44, 147456
s_mov_b32 m0, s45
s_add_u32 s45, s45, 16384
buffer_load_dwordx4 v16, s[12:15], s44 offen nt lds
s_add_u32 s44, s44, 147456
s_branch L_sl0_d
L_sl0_m:
s_cmp_eq_u32 s50, 255
s_cbranch_scc1 L_sl0_d
s_add_u32 s52, s52, 256
v_add_u32 v16, s52, v14
s_mul_i32 s44, s3, 55296
s_lshl_b32 s45, s3, 10
s_add_u32 s45, s45, 0
s_mov_b32 m0, s45
s_add_u32 s45, s45, 16384
buffer_load_dwordx4 v16, s[8:11], s44 offen nt lds
s_add_u32 s44, s44, 884736
s_mov_b32 m0, s45
s_add_u32 s45, s45, 16384
buffer_load_dwordx4 v16, s[8:11], s44 offen nt lds
s_add_u32 s44, s44, 884736
s_mov_b32 m0, s45
s_add_u32 s45, s45, 16384
buffer_load_dwordx4 v16, s[8:11], s44 offen nt lds
s_add_u32 s44, s44, 884736
s_mov_b32 m0, s45
s_add_u32 s45, s45, 16384
buffer_load_dwordx4 v16, s[8:11], s44 offen nt lds
s_add_u32 s44, s44, 884736
s_cmp_ge_u32 s3, 8
s_cbranch_scc1 DS_19
s_mov_b32 m0, s45
s_add_u32 s45, s45, 16384
buffer_load_dwordx4 v16, s[8:11], s44 offen nt lds
s_add_u32 s44, s44, 884736
DS_19:
L_sl0_d:
s_lshl_b32 s52, s51, 7
s_cmp_ge_u32 s51, 16
s_cbranch_scc1 L_sl1_m
v_add_u32 v16, s52, v19
s_mul_i32 s44, s3, 9216
s_lshl_b32 s45, s3, 10
s_add_u32 s45, s45, 73728
s_mov_b32 m0, s45
s_add_u32 s45, s45, 16384
buffer_load_dwordx4 v16, s[12:15], s44 offen nt lds
s_add_u32 s44, s44, 147456
s_mov_b32 m0, s45
s_add_u32 s45, s45, 16384
buffer_load_dwordx4 v16, s[12:15], s44 offen nt lds
s_add_u32 s44, s44, 147456
s_mov_b32 m0, s45
s_add_u32 s45, s45, 16384
buffer_load_dwordx4 v16, s[12:15], s44 offen nt lds
s_add_u32 s44, s44, 147456
s_mov_b32 m0, s45
s_add_u32 s45, s45, 16384
buffer_load_dwordx4 v16, s[12:15], s44 offen nt lds
s_add_u32 s44, s44, 147456
s_branch L_sl1_d
L_sl1_m:
s_cmp_eq_u32 s51, 255
s_cbranch_scc1 L_sl1_d
s_add_u32 s52, s52, 256
v_add_u32 v16, s52, v14
s_mul_i32 s44, s3, 55296
s_lshl_b32 s45, s3, 10
s_add_u32 s45, s45, 73728
s_mov_b32 m0, s45
s_add_u32 s45, s45, 16384
buffer_load_dwordx4 v16, s[8:11], s44 offen nt lds
s_add_u32 s44, s44, 884736
s_mov_b32 m0, s45
s_add_u32 s45, s45, 16384
buffer_load_dwordx4 v16, s[8:11], s44 offen nt lds
s_add_u32 s44, s44, 884736
s_mov_b32 m0, s45
s_add_u32 s45, s45, 16384
buffer_load_dwordx4 v16, s[8:11], s44 offen nt lds
s_add_u32 s44, s44, 884736
s_mov_b32 m0, s45
s_add_u32 s45, s45, 16384
buffer_load_dwordx4 v16, s[8:11], s44 offen nt lds
s_add_u32 s44, s44, 884736
s_cmp_ge_u32 s3, 8
s_cbranch_scc1 DS_20
s_mov_b32 m0, s45
s_add_u32 s45, s45, 16384
buffer_load_dwordx4 v16, s[8:11], s44 offen nt lds
s_add_u32 s44, s44, 884736
DS_20:
L_sl1_d:
s_cmp_lg_u32 s3, 4
s_cbranch_scc1 L_M_tr2
s_sub_u32 s52, s5, 9
s_bitcmp0_b32 96, s52
s_cbranch_scc1 L_M_tr2
s_lshl_b32 s52, s4, 3
s_add_u32 s52, s52, s5
s_lshl_b32 s52, s52, 7
s_add_u32 s52, s52, 97152
v_mov_b32 v21, s52
v_mov_b32 v22, s6
s_mov_b64 exec, 1
s_waitcnt vmcnt(6)
global_store_dword v21, v22, s[42:43]
s_mov_b64 exec, -1
L_M_tr2:
s_waitcnt vmcnt(0)
s_cmp_ge_u32 s3, 9
s_cbranch_scc1 L_M_ld
s_cmp_lt_u32 s55, 36
s_cbranch_scc1 L_M_ld
v_lshlrev_b32 v36, 16, v36
v_lshlrev_b32 v37, 16, v37
v_mul_f32 v34, 0xbfb8aa3b, v36
v_mul_f32 v35, 0xbfb8aa3b, v37
v_exp_f32 v34, v34
v_exp_f32 v35, v35
s_nop 0
v_add_f32 v34, 1.0, v34
v_add_f32 v35, 1.0, v35
v_min_f32 v34, 0x7f000000, v34
v_min_f32 v35, 0x7f000000, v35
v_rcp_f32 v38, v34
v_rcp_f32 v39, v35
s_nop 0
v_mul_f32 v40, v36, v38
v_mul_f32 v41, v37, v39
v_fma_f32 v36, -v40, v34, v36
v_fma_f32 v37, -v41, v35, v37
v_fmac_f32 v40, v36, v38
v_fmac_f32 v41, v37, v39
v_cvt_pk_bf16_f32 v36, v40, v41
ds_write_b16 v2, v36
ds_write_b16_d16_hi v2, v36 offset:4736
s_waitcnt lgkmcnt(0)
L_M_ld:
s_barrier
s_cmp_lt_u32 s3, 8
s_cbranch_scc1 L_H_p
s_cmp_ge_u32 s3, 12
s_cselect_b32 s50, s51, s50
s_cselect_b32 s44, 73728, 0
v_add_u32 v17, s44, v10
s_cmp_lt_u32 s50, 16
s_cbranch_scc1 L_A_s4m
s_cmp_eq_u32 s50, 255
s_cbranch_scc1 L_H_x
s_lshl_b32 s44, s50, 9
s_lshl_b32 s45, s46, 7
s_add_u32 s44, s44, s45
s_add_u32 s44, s44, 253952
v_lshl_add_u32 v18, v1, 3, s44
ds_read_b64_tr_b16 v[52:53], v17 offset:0
ds_read_b64_tr_b16 v[54:55], v17 offset:2048
ds_read_b64_tr_b16 v[56:57], v17 offset:4096
ds_read_b64_tr_b16 v[58:59], v17 offset:6144
ds_read_b64_tr_b16 v[60:61], v17 offset:8192
ds_read_b64_tr_b16 v[62:63], v17 offset:10240
ds_read_b64_tr_b16 v[64:65], v17 offset:12288
ds_read_b64_tr_b16 v[66:67], v17 offset:14336
ds_read_b64_tr_b16 v[68:69], v17 offset:16384
ds_read_b64_tr_b16 v[70:71], v17 offset:18432
ds_read_b64_tr_b16 v[72:73], v17 offset:20480
ds_read_b64_tr_b16 v[74:75], v17 offset:22528
ds_read_b64_tr_b16 v[76:77], v17 offset:24576
ds_read_b64_tr_b16 v[78:79], v17 offset:26624
ds_read_b64_tr_b16 v[80:81], v17 offset:28672
ds_read_b64_tr_b16 v[82:83], v17 offset:30720
ds_read_b64_tr_b16 v[84:85], v17 offset:32768
ds_read_b64_tr_b16 v[86:87], v17 offset:34816
ds_read_b64_tr_b16 v[88:89], v17 offset:36864
ds_read_b64_tr_b16 v[90:91], v17 offset:38912
ds_read_b64_tr_b16 v[92:93], v17 offset:40960
ds_read_b64_tr_b16 v[94:95], v17 offset:43008
ds_read_b64_tr_b16 v[96:97], v17 offset:45056
ds_read_b64_tr_b16 v[98:99], v17 offset:47104
ds_read_b64_tr_b16 v[100:101], v17 offset:49152
ds_read_b64_tr_b16 v[102:103], v17 offset:51200
ds_read_b64_tr_b16 v[104:105], v17 offset:53248
ds_read_b64_tr_b16 v[106:107], v17 offset:55296
ds_read_b64_tr_b16 v[108:109], v17 offset:57344
ds_read_b64_tr_b16 v[110:111], v17 offset:59392
ds_read_b64_tr_b16 v[112:113], v17 offset:61440
ds_read_b64_tr_b16 v[114:115], v17 offset:63488
v_add_u32 v17, 65536, v17
ds_read_b64_tr_b16 v[116:117], v17 offset:0
ds_read_b64_tr_b16 v[118:119], v17 offset:2048
ds_read_b64_tr_b16 v[120:121], v17 offset:4096
ds_read_b64_tr_b16 v[122:123], v17 offset:6144
v_bfe_u32 v15, v1, 1, 1
v_mul_u32_u24 v15, 4736, v15
v_add_u32 v15, v11, v15
v_bfe_i32 v16, v1, 0, 1
v_and_b32 v16, 0xaaaa, v16
v_or_b32 v16, 0x4444, v16
v_mov_b32 v20, 0
v_mov_b32 v21, 0
v_mov_b32 v22, 0
v_mov_b32 v23, 0
ds_read_b128 v[24:27], v15 offset:0
ds_read_b128 v[28:31], v15 offset:128
ds_read_b128 v[32:35], v15 offset:256
ds_read_b128 v[36:39], v15 offset:384
ds_read_b128 v[40:43], v15 offset:512
ds_read_b128 v[44:47], v15 offset:640
ds_read_b128 v[48:51], v15 offset:768
s_waitcnt lgkmcnt(6)
v_smfmac_f32_16x16x64_bf16 v[20:23], v[24:27], v[52:59], v16
ds_read_b128 v[24:27], v15 offset:896
s_waitcnt lgkmcnt(6)
v_smfmac_f32_16x16x64_bf16 v[20:23], v[28:31], v[60:67], v16
ds_read_b128 v[28:31], v15 offset:1024
s_waitcnt lgkmcnt(6)
v_smfmac_f32_16x16x64_bf16 v[20:23], v[32:35], v[68:75], v16
s_waitcnt lgkmcnt(5)
v_smfmac_f32_16x16x64_bf16 v[20:23], v[36:39], v[76:83], v16
s_waitcnt lgkmcnt(4)
v_smfmac_f32_16x16x64_bf16 v[20:23], v[40:43], v[84:91], v16
s_waitcnt lgkmcnt(3)
v_smfmac_f32_16x16x64_bf16 v[20:23], v[44:47], v[92:99], v16
s_waitcnt lgkmcnt(2)
v_smfmac_f32_16x16x64_bf16 v[20:23], v[48:51], v[100:107], v16
s_waitcnt lgkmcnt(1)
v_smfmac_f32_16x16x64_bf16 v[20:23], v[24:27], v[108:115], v16
s_waitcnt lgkmcnt(0)
v_smfmac_f32_16x16x64_bf16 v[20:23], v[28:31], v[116:123], v16
s_mov_b64 exec, 0xffff
s_nop 6
v_add_f32 v20, v20, v21
v_add_f32 v21, v22, v23
v_cvt_pk_bf16_f32 v22, v20, v21
v_mov_b32 v23, s6
global_store_dwordx2 v18, v[22:23], s[42:43] sc1
s_mov_b64 exec, -1
L_H_x:
s_branch L_end
L_H_p:
s_cmp_ge_u32 s5, 14
s_cbranch_scc1 L_H_x
s_lshl_b32 s50, s4, 4
s_lshr_b32 s45, s3, 1
s_lshl_b32 s45, s45, 2
s_add_u32 s50, s50, s45
s_and_b32 s44, s3, 1
s_lshl_b32 s51, s50, 7
s_add_u32 s51, s51, 1179648
v_bfe_u32 v18, v1, 2, 2
v_lshlrev_b32 v18, 7, v18
v_lshl_add_u32 v18, v9, 2, v18
v_add_u32 v18, s51, v18
s_lshl_b32 s51, s50, 10
s_lshl_b32 s45, s44, 9
s_add_u32 s51, s51, s45
s_add_u32 s51, s51, 1048576
v_lshl_add_u32 v17, v1, 3, s51
s_bfe_u32 s45, s3, 0x10001
s_mul_i32 s45, s45, 1184
s_lshr_b32 s51, s3, 2
s_lshl_b32 s51, s51, 9
s_add_u32 s45, s45, s51
s_and_b32 s51, s3, 6
s_lshl_b32 s51, s51, 7
s_sub_u32 s45, s45, s51
s_add_u32 s45, s45, 1184
v_add_u32 v19, s45, v2
s_mov_b32 s7, 0
L_A_ml:
s_add_u32 s7, s7, 1
s_cmp_gt_u32 s7, 400000
s_cbranch_scc1 L_end
s_cmp_lg_u32 s7, 300
s_cbranch_scc1 L_A_ml_k
v_add_u32 v17, 524288, v17
v_add_u32 v18, 524288, v18
L_A_ml_k:
global_load_dword v20, v18, s[42:43] sc1
s_waitcnt vmcnt(0)
v_xor_b32 v20, s101, v20
v_and_b32 v21, 63, v20
v_cmp_ne_u32 vcc, 0, v21
s_cbranch_vccnz L_A_ml
global_load_dwordx2 v[32:33], v17, s[42:43] offset:0 sc1
global_load_dwordx2 v[34:35], v17, s[42:43] offset:1024 sc1
global_load_dwordx2 v[36:37], v17, s[42:43] offset:2048 sc1
global_load_dwordx2 v[38:39], v17, s[42:43] offset:3072 sc1
v_max_f32_dpp v21, v20, v20 row_ror:4 row_mask:0xf bank_mask:0xf
v_mov_b32_dpp v23, v20 quad_perm:[1,1,3,3] row_mask:0xf bank_mask:0xf
s_nop 0
v_max_f32_dpp v21, v21, v21 row_ror:8 row_mask:0xf bank_mask:0xf
v_sub_f32 v22, v20, v21
v_mul_f32 v22, 0x3fb8aa3b, v22
v_exp_f32 v22, v22
s_nop 0
v_mul_f32 v23, v22, v23
s_nop 1
v_add_f32_dpp v23, v23, v23 row_ror:4 row_mask:0xf bank_mask:0xf
s_nop 1
v_add_f32_dpp v23, v23, v23 row_ror:8 row_mask:0xf bank_mask:0xf
v_rcp_f32 v23, v23
s_nop 0
v_mul_f32 v22, v22, v23
s_branch L_A_ochk
L_A_h3:
s_add_u32 s7, s7, 1
s_cmp_gt_u32 s7, 400000
s_cbranch_scc1 L_end
s_cmp_lg_u32 s7, 300
s_cbranch_scc1 L_A_h3_k
v_add_u32 v17, 524288, v17
L_A_h3_k:
global_load_dwordx2 v[32:33], v17, s[42:43] offset:0 sc1
global_load_dwordx2 v[34:35], v17, s[42:43] offset:1024 sc1
global_load_dwordx2 v[36:37], v17, s[42:43] offset:2048 sc1
global_load_dwordx2 v[38:39], v17, s[42:43] offset:3072 sc1
L_A_ochk:
s_waitcnt vmcnt(3)
v_xor_b32 v32, s101, v32
v_xor_b32 v33, s101, v33
v_or_b32 v20, v32, v33
v_mul_f32_dpp v30, v22, v32 row_newbcast:0 row_mask:0xf bank_mask:0xf
v_mul_f32_dpp v31, v22, v33 row_newbcast:2 row_mask:0xf bank_mask:0xf
s_waitcnt vmcnt(2)
v_xor_b32 v34, s101, v34
v_xor_b32 v35, s101, v35
v_or3_b32 v20, v34, v35, v20
v_fmac_f32_dpp v30, v22, v34 row_newbcast:4 row_mask:0xf bank_mask:0xf
v_fmac_f32_dpp v31, v22, v35 row_newbcast:6 row_mask:0xf bank_mask:0xf
s_waitcnt vmcnt(1)
v_xor_b32 v36, s101, v36
v_xor_b32 v37, s101, v37
v_or3_b32 v20, v36, v37, v20
v_fmac_f32_dpp v30, v22, v36 row_newbcast:8 row_mask:0xf bank_mask:0xf
v_fmac_f32_dpp v31, v22, v37 row_newbcast:10 row_mask:0xf bank_mask:0xf
s_waitcnt vmcnt(0)
v_xor_b32 v38, s101, v38
v_xor_b32 v39, s101, v39
v_or3_b32 v20, v38, v39, v20
v_fmac_f32_dpp v30, v22, v38 row_newbcast:12 row_mask:0xf bank_mask:0xf
v_fmac_f32_dpp v31, v22, v39 row_newbcast:14 row_mask:0xf bank_mask:0xf
v_and_b32 v20, 63, v20
v_cmp_ne_u32 vcc, 0, v20
s_cbranch_vccnz L_A_h3
v_cvt_pk_bf16_f32 v30, v30, v31
ds_write_b16 v19, v30
ds_write_b16_d16_hi v19, v30 offset:256
s_waitcnt lgkmcnt(0)
s_barrier
s_branch L_end
L_A_s4m:
v_bfe_u32 v18, v1, 1, 1
v_mul_u32_u24 v18, 1184, v18
v_add_u32 v18, v18, v11
v_add_u32 v18, 1184, v18
s_mul_i32 s45, s4, 4608
s_lshl_b32 s44, s50, 9
s_add_u32 s45, s45, s44
s_lshl_b32 s44, s46, 7
s_add_u32 s45, s45, s44
s_add_u32 s45, s45, 131072
v_lshl_add_u32 v19, v1, 4, s45
ds_read_b64_tr_b16 v[56:57], v17 offset:0
ds_read_b64_tr_b16 v[58:59], v17 offset:2048
ds_read_b64_tr_b16 v[60:61], v17 offset:4096
ds_read_b64_tr_b16 v[62:63], v17 offset:6144
ds_read_b64_tr_b16 v[64:65], v17 offset:8192
ds_read_b64_tr_b16 v[66:67], v17 offset:10240
ds_read_b64_tr_b16 v[68:69], v17 offset:12288
ds_read_b64_tr_b16 v[70:71], v17 offset:14336
ds_read_b64_tr_b16 v[72:73], v17 offset:16384
ds_read_b64_tr_b16 v[74:75], v17 offset:18432
ds_read_b64_tr_b16 v[76:77], v17 offset:20480
ds_read_b64_tr_b16 v[78:79], v17 offset:22528
ds_read_b64_tr_b16 v[80:81], v17 offset:24576
ds_read_b64_tr_b16 v[82:83], v17 offset:26624
ds_read_b64_tr_b16 v[84:85], v17 offset:28672
ds_read_b64_tr_b16 v[86:87], v17 offset:30720
ds_read_b64_tr_b16 v[88:89], v17 offset:32768
ds_read_b64_tr_b16 v[90:91], v17 offset:34816
ds_read_b64_tr_b16 v[92:93], v17 offset:36864
ds_read_b64_tr_b16 v[94:95], v17 offset:38912
ds_read_b64_tr_b16 v[96:97], v17 offset:40960
ds_read_b64_tr_b16 v[98:99], v17 offset:43008
ds_read_b64_tr_b16 v[100:101], v17 offset:45056
ds_read_b64_tr_b16 v[102:103], v17 offset:47104
ds_read_b64_tr_b16 v[104:105], v17 offset:49152
ds_read_b64_tr_b16 v[106:107], v17 offset:51200
ds_read_b64_tr_b16 v[108:109], v17 offset:53248
ds_read_b64_tr_b16 v[110:111], v17 offset:55296
ds_read_b64_tr_b16 v[112:113], v17 offset:57344
ds_read_b64_tr_b16 v[114:115], v17 offset:59392
ds_read_b64_tr_b16 v[116:117], v17 offset:61440
ds_read_b64_tr_b16 v[118:119], v17 offset:63488
v_bfe_i32 v16, v1, 0, 1
v_and_b32 v16, 0xaaaa, v16
v_or_b32 v16, 0x4444, v16
v_mov_b32 v20, 0
v_mov_b32 v21, 0
v_mov_b32 v22, 0
v_mov_b32 v23, 0
s_waitcnt lgkmcnt(0)
s_barrier
ds_read_b128 v[24:27], v18 offset:0
ds_read_b128 v[28:31], v18 offset:128
ds_read_b128 v[32:35], v18 offset:256
ds_read_b128 v[36:39], v18 offset:384
ds_read_b128 v[40:43], v18 offset:512
ds_read_b128 v[44:47], v18 offset:640
ds_read_b128 v[48:51], v18 offset:768
ds_read_b128 v[52:55], v18 offset:896
s_waitcnt lgkmcnt(7)
v_smfmac_f32_16x16x64_bf16 v[20:23], v[24:27], v[56:63], v16
s_waitcnt lgkmcnt(6)
v_smfmac_f32_16x16x64_bf16 v[20:23], v[28:31], v[64:71], v16
s_waitcnt lgkmcnt(5)
v_smfmac_f32_16x16x64_bf16 v[20:23], v[32:35], v[72:79], v16
s_waitcnt lgkmcnt(4)
v_smfmac_f32_16x16x64_bf16 v[20:23], v[36:39], v[80:87], v16
s_waitcnt lgkmcnt(3)
v_smfmac_f32_16x16x64_bf16 v[20:23], v[40:43], v[88:95], v16
s_waitcnt lgkmcnt(2)
v_smfmac_f32_16x16x64_bf16 v[20:23], v[44:47], v[96:103], v16
s_waitcnt lgkmcnt(1)
v_smfmac_f32_16x16x64_bf16 v[20:23], v[48:51], v[104:111], v16
s_waitcnt lgkmcnt(0)
v_smfmac_f32_16x16x64_bf16 v[20:23], v[52:55], v[112:119], v16
s_mov_b64 exec, 0xffff
s_nop 6
v_add_f32 v20, v20, v21
v_add_f32 v21, v22, v23
v_bfi_b32 v24, 63, s101, v20
v_bfi_b32 v25, 63, s101, v21
s_nop 0
v_mov_b32_dpp v26, v24 row_ror:8 row_mask:0xf bank_mask:0xf
v_mov_b32_dpp v27, v25 row_ror:8 row_mask:0xf bank_mask:0xf
s_mov_b64 exec, 0xff
global_store_dwordx4 v19, v[24:27], s[42:43] sc1
s_mov_b64 exec, -1
s_branch L_end
L_KT:
s_waitcnt lgkmcnt(0)
s_add_u32 s6, s6, 0x9e3779b9
s_and_b32 s101, s6, 63
s_and_b32 s100, s6, 7
s_cmp_ge_u32 s3, 9
s_cbranch_scc1 L_S5
v_lshlrev_b32 v15, 1, v0
global_load_ushort v33, v15, s[16:17]
global_load_ushort v34, v15, s[16:17] offset:1152
s_mul_i32 s44, s4, 4608
s_add_u32 s44, s44, 1384448
v_lshl_add_u32 v55, v0, 3, s44
global_load_dword v57, v55, s[42:43] sc1
v_mul_u32_u24 v15, 36, v1
global_load_dwordx4 v[24:27], v15, s[16:17]
global_load_dwordx4 v[28:31], v15, s[16:17] offset:16
global_load_dword v32, v15, s[16:17] offset:32
v_lshlrev_b32 v15, 3, v0
v_and_b32 v15, -16, v0
v_lshlrev_b32 v15, 3, v15
v_lshl_or_b32 v15, v7, 4, v15
v_and_b32 v39, 8, v0
v_or_b32 v15, v15, v39
v_add_u32 v52, 198912, v15
v_add_u32 v53, 208128, v15
s_mov_b32 s44, 0x3f803f80
v_mov_b32 v35, 0
v_mov_b32 v36, 0
s_waitcnt vmcnt(0)
v_mov_b32 v61, s6
v_dot2_f32_bf16 v35, v24, s44, v35
v_dot2_f32_bf16 v36, v24, v24, v36
v_dot2_f32_bf16 v35, v25, s44, v35
v_dot2_f32_bf16 v36, v25, v25, v36
v_dot2_f32_bf16 v35, v26, s44, v35
v_dot2_f32_bf16 v36, v26, v26, v36
v_dot2_f32_bf16 v35, v27, s44, v35
v_dot2_f32_bf16 v36, v27, v27, v36
v_dot2_f32_bf16 v35, v28, s44, v35
v_dot2_f32_bf16 v36, v28, v28, v36
v_dot2_f32_bf16 v35, v29, s44, v35
v_dot2_f32_bf16 v36, v29, v29, v36
v_dot2_f32_bf16 v35, v30, s44, v35
v_dot2_f32_bf16 v36, v30, v30, v36
v_dot2_f32_bf16 v35, v31, s44, v35
v_dot2_f32_bf16 v36, v31, v31, v36
v_dot2_f32_bf16 v35, v32, s44, v35
v_dot2_f32_bf16 v36, v32, v32, v36
s_nop 2
s_nop 0
v_add_f32_dpp v35, v35, v35 quad_perm:[1,0,3,2] row_mask:0xf bank_mask:0xf
v_add_f32_dpp v36, v36, v36 quad_perm:[1,0,3,2] row_mask:0xf bank_mask:0xf
s_nop 0
v_add_f32_dpp v35, v35, v35 quad_perm:[2,3,0,1] row_mask:0xf bank_mask:0xf
v_add_f32_dpp v36, v36, v36 quad_perm:[2,3,0,1] row_mask:0xf bank_mask:0xf
s_nop 0
v_add_f32_dpp v35, v35, v35 row_half_mirror row_mask:0xf bank_mask:0xf
v_add_f32_dpp v36, v36, v36 row_half_mirror row_mask:0xf bank_mask:0xf
s_nop 0
v_add_f32_dpp v35, v35, v35 row_mirror row_mask:0xf bank_mask:0xf
v_add_f32_dpp v36, v36, v36 row_mirror row_mask:0xf bank_mask:0xf
v_mov_b32 v37, v35
v_mov_b32 v38, v36
s_nop 0
v_permlane16_swap_b32 v35, v37
v_permlane16_swap_b32 v36, v38
v_add_f32 v35, v35, v37
v_add_f32 v36, v36, v38
v_mul_f32 v35, 0x3ae38e39, v35
v_mul_f32 v36, 0x3ae38e39, v36
v_fma_f32 v36, -v35, v35, v36
v_max_f32 v36, 0, v36
v_cvt_pk_bf16_f32 v35, 0, v35
v_cvt_pk_bf16_f32 v36, 0, v36
v_add_f32 v36, 0x3727c5ac, v36
v_cvt_pk_bf16_f32 v36, 0, v36
v_sqrt_f32 v36, v36
s_nop 0
v_cvt_pk_bf16_f32 v36, 0, v36
v_rcp_f32 v38, v36
s_nop 0
v_readlane_b32 s48, v35, 0
v_readlane_b32 s49, v35, 32
v_readlane_b32 s50, v38, 0
v_readlane_b32 s51, v38, 32
v_readlane_b32 s52, v36, 0
v_readlane_b32 s53, v36, 32
v_lshlrev_b32 v33, 16, v33
v_lshlrev_b32 v34, 16, v34
v_subrev_f32 v33, s48, v33
v_subrev_f32 v34, s49, v34
v_cvt_pk_bf16_f32 v33, 0, v33
v_cvt_pk_bf16_f32 v34, 0, v34
v_mul_f32 v37, s50, v33
v_mul_f32 v38, s51, v34
v_fma_f32 v33, -v37, s52, v33
v_fma_f32 v34, -v38, s53, v34
v_fma_f32 v33, v33, s50, v37
v_fma_f32 v34, v34, s51, v38
v_cvt_pk_bf16_f32 v33, 0, v33
v_cvt_pk_bf16_f32 v34, 0, v34
s_mov_b32 s7, 0
L_HR_h:
s_add_u32 s7, s7, 1
s_cmp_gt_u32 s7, 400000
s_cbranch_scc1 L_end
s_sleep 2
global_load_dwordx2 v[40:41], v52, s[42:43] offset:-2304 sc1
global_load_dwordx2 v[42:43], v52, s[42:43] offset:2304 sc1
global_load_dwordx2 v[44:45], v53, s[42:43] offset:-2304 sc1
global_load_dwordx2 v[46:47], v53, s[42:43] offset:2304 sc1
s_waitcnt vmcnt(0)
v_xor_b32 v40, s100, v40
v_xor_b32 v41, s100, v41
v_or_b32 v39, v40, v41
v_xor_b32 v42, s100, v42
v_xor_b32 v43, s100, v43
v_or3_b32 v39, v42, v43, v39
v_xor_b32 v44, s100, v44
v_xor_b32 v45, s100, v45
v_or3_b32 v39, v44, v45, v39
v_xor_b32 v46, s100, v46
v_xor_b32 v47, s100, v47
v_or3_b32 v39, v46, v47, v39
v_and_b32 v39, 7, v39
v_cmp_ne_u32 vcc, 0, v39
s_cbranch_vccnz L_HR_h
v_add_f32 v40, v40, v44
v_add_f32 v41, v41, v45
v_add_f32 v42, v42, v46
v_add_f32 v43, v43, v47
v_cvt_pk_bf16_f32 v40, 0, v40
v_cvt_pk_bf16_f32 v41, 0, v41
v_cvt_pk_bf16_f32 v42, 0, v42
v_cvt_pk_bf16_f32 v43, 0, v43
v_add_f32 v42, 1.0, v42
v_add_f32 v43, 1.0, v43
v_cvt_pk_bf16_f32 v42, 0, v42
v_cvt_pk_bf16_f32 v43, 0, v43
v_mul_f32 v42, v33, v42
v_mul_f32 v43, v34, v43
v_cvt_pk_bf16_f32 v42, 0, v42
v_cvt_pk_bf16_f32 v43, 0, v43
v_add_f32 v42, v42, v40
v_add_f32 v43, v43, v41
v_cvt_pk_bf16_f32 v60, v42, v43
global_store_dwordx2 v55, v[60:61], s[42:43]
v_add_u32 v55, 524288, v55
global_store_dwordx2 v55, v[60:61], s[42:43] sc1
s_branch L_S5
L_S5:
s_mul_i32 s47, s4, 9
s_lshr_b32 s44, s28, 7
s_add_u32 s44, s44, s4
s_sub_u32 s44, 3, s44
s_and_b32 s44, s44, 7
s_cmp_eq_u32 s5, s44
s_cselect_b32 s45, 8, s5
s_cmp_eq_u32 s5, 8
s_cselect_b32 s45, s44, s45
s_add_u32 s47, s47, s45
s_mov_b32 s8, s28
s_and_b32 s9, s29, 0xffff
s_mov_b32 s10, 5308416
s_mov_b32 s11, 0x20000
s_mov_b32 s12, s32
s_and_b32 s13, s33, 0xffff
s_mov_b32 s14, 5308416
s_mov_b32 s15, 0x20000
s_lshl_b32 s44, s47, 7
v_mul_u32_u24 v14, 9216, v4
v_lshl_add_u32 v14, v6, 4, v14
v_add_u32 v14, s44, v14
s_lshl_b32 s45, s46, 5
s_add_u32 s44, s44, s45
v_and_b32 v15, 15, v1
v_lshl_add_u32 v15, v15, 1, s44
global_load_ushort v19, v15, s[30:31]
v_add_u32 v16, 0, v0
v_mul_u32_u24 v17, 0xe39, v16
v_lshrrev_b32 v17, 18, v17
v_and_b32 v17, 6, v17
v_xor_b32 v16, v16, v17
v_lshlrev_b32 v96, 4, v16
v_add_u32 v16, 1024, v0
v_mul_u32_u24 v17, 0xe39, v16
v_lshrrev_b32 v17, 18, v17
v_and_b32 v17, 6, v17
v_xor_b32 v16, v16, v17
v_lshlrev_b32 v97, 4, v16
v_add_u32 v16, 2048, v0
v_mul_u32_u24 v17, 0xe39, v16
v_lshrrev_b32 v17, 18, v17
v_and_b32 v17, 6, v17
v_xor_b32 v16, v16, v17
v_lshlrev_b32 v98, 4, v16
v_add_u32 v16, 3072, v0
v_mul_u32_u24 v17, 0xe39, v16
v_lshrrev_b32 v17, 18, v17
v_and_b32 v17, 6, v17
v_xor_b32 v16, v16, v17
v_lshlrev_b32 v99, 4, v16
v_add_u32 v16, 4096, v0
v_mul_u32_u24 v17, 0xe39, v16
v_lshrrev_b32 v17, 18, v17
v_and_b32 v17, 6, v17
v_xor_b32 v16, v16, v17
v_lshlrev_b32 v100, 4, v16
s_mul_i32 s49, s4, 9216
s_add_u32 s45, s49, 1196032
v_lshl_add_u32 v80, v0, 4, s45
s_add_u32 s45, s49, 1269760
v_lshl_add_u32 v81, v0, 4, s45
v_lshrrev_b32 v20, 2, v1
v_mul_u32_u24 v20, 1152, v20
v_lshl_add_u32 v20, v9, 3, v20
v_add_u32 v20, 73728, v20
v_bfe_u32 v17, v1, 3, 2
s_mul_i32 s48, s3, 3
s_add_u32 s44, s48, 0
v_xor_b32 v92, s44, v17
v_lshl_add_u32 v92, v92, 5, v20
s_add_u32 s44, s48, 1
v_xor_b32 v93, s44, v17
v_lshl_add_u32 v93, v93, 5, v20
s_add_u32 s44, s48, 2
v_xor_b32 v94, s44, v17
v_lshl_add_u32 v94, v94, 5, v20
s_mul_i32 s44, s48, 9216
s_lshl_b32 s45, s47, 6
s_add_u32 s44, s44, s45
s_add_u32 s44, s44, 327680
v_mul_u32_u24 v20, 4608, v4
v_lshl_add_u32 v20, v7, 3, v20
v_add_u32 v76, s44, v20
v_lshlrev_b32 v79, 6, v9
v_and_b32 v20, 48, v1
v_add_u32 v79, v79, v20
v_add_u32 v79, 156928, v79
s_lshl_b32 s44, s47, 3
v_add_u32 v77, s44, v7
v_lshrrev_b32 v78, 5, v1
v_mul_u32_u24 v82, 1152, v78
v_lshl_add_u32 v82, v77, 1, v82
v_lshlrev_b32 v83, 1, v77
s_cmp_lg_u32 s3, 10
s_cbranch_scc1 L_S5_nf
global_load_ushort v84, v83, s[34:35]
L_S5_nf:
v_lshlrev_b32 v83, 3, v77
v_add_u32 v83, 275968, v83
s_add_u32 s44, s49, 1269768
v_lshl_add_u32 v77, v77, 4, s44
v_lshlrev_b32 v78, 4, v78
s_mul_i32 s44, s47, 4608
s_add_u32 s44, s44, 329728
v_lshl_add_u32 v88, v1, 3, s44
v_mov_b32 v21, 157248
v_mov_b32 v22, 1
s_cmp_lg_u32 s3, 11
s_cbranch_scc1 L_S5_tb
s_lshr_b32 s44, s28, 7
s_add_u32 s44, s44, s47
s_and_b32 s44, s44, 7
s_cmp_eq_u32 s44, 3
s_cbranch_scc1 L_S5_tb
s_lshl_b32 s44, s4, 10
s_add_u32 s44, s44, 98304
v_lshl_add_u32 v16, v7, 7, s44
s_mov_b32 s7, 0
L_S5_trig:
s_sleep 2
global_load_dword v17, v16, s[42:43] sc1
s_add_u32 s7, s7, 1
s_cmp_gt_u32 s7, 150
s_cbranch_scc1 L_S5_tb
s_waitcnt vmcnt(0)
v_cmp_eq_u32 vcc, s6, v17
s_and_b32 s44, vcc_lo, 96
s_bcnt1_i32_b32 s44, s44
s_cmp_lt_u32 s44, 1
s_cbranch_scc1 L_S5_trig
L_S5_tb:
s_barrier
s_mul_i32 s44, s3, 73728
s_lshl_b32 s45, s3, 10
s_add_u32 s45, s45, 0
s_mov_b32 m0, s45
s_add_u32 s45, s45, 16384
buffer_load_dwordx4 v14, s[8:11], s44 offen nt lds
s_add_u32 s44, s44, 1179648
s_mov_b32 m0, s45
s_add_u32 s45, s45, 16384
buffer_load_dwordx4 v14, s[8:11], s44 offen nt lds
s_add_u32 s44, s44, 1179648
s_mov_b32 m0, s45
s_add_u32 s45, s45, 16384
buffer_load_dwordx4 v14, s[8:11], s44 offen nt lds
s_add_u32 s44, s44, 1179648
s_mov_b32 m0, s45
s_add_u32 s45, s45, 16384
buffer_load_dwordx4 v14, s[8:11], s44 offen nt lds
s_add_u32 s44, s44, 1179648
s_cmp_ge_u32 s3, 8
s_cbranch_scc1 DS_21
s_mov_b32 m0, s45
s_add_u32 s45, s45, 16384
buffer_load_dwordx4 v14, s[8:11], s44 offen nt lds
s_add_u32 s44, s44, 1179648
DS_21:
s_barrier
s_mul_i32 s44, s47, 73728
s_lshl_b32 s45, s3, 10
s_add_u32 s45, s45, 139264
s_cmp_ge_u32 s3, 8
s_cbranch_scc1 L_S5_w4
s_mov_b32 m0, s45
s_nop 0
buffer_load_dwordx4 v100, s[12:15], s44 offen nt lds
L_S5_w4:
s_sub_u32 s45, s45, 16384
s_mov_b32 m0, s45
s_nop 0
buffer_load_dwordx4 v99, s[12:15], s44 offen nt lds
s_sub_u32 s45, s45, 16384
s_mov_b32 m0, s45
s_nop 0
buffer_load_dwordx4 v98, s[12:15], s44 offen nt lds
s_sub_u32 s45, s45, 16384
s_mov_b32 m0, s45
s_nop 0
buffer_load_dwordx4 v97, s[12:15], s44 offen nt lds
s_sub_u32 s45, s45, 16384
s_mov_b32 m0, s45
s_nop 0
buffer_load_dwordx4 v96, s[12:15], s44 offen nt lds
s_cmp_ge_u32 s3, 9
s_cbranch_scc1 L_S5_hi
global_load_dwordx4 v[24:27], v80, s[42:43] sc1
s_waitcnt vmcnt(5)
s_mov_b64 exec, 1
ds_add_u32 v21, v22 offset:4
s_mov_b64 exec, -1
s_mov_b32 s7, 0
s_branch L_S5_rgc
L_S5_rg:
s_add_u32 s7, s7, 1
s_cmp_gt_u32 s7, 400000
s_cbranch_scc1 L_end
s_cmp_lg_u32 s7, 300
s_cbranch_scc1 L_S5_rg_k
v_add_u32 v80, 524288, v80
v_add_u32 v81, 524288, v81
L_S5_rg_k:
s_sleep 2
global_load_dwordx4 v[24:27], v80, s[42:43] sc1
L_S5_rgc:
s_waitcnt vmcnt(0)
v_min3_u32 v30, v25, v27, s6
v_max3_u32 v31, v25, v27, s6
v_cmp_ne_u32 vcc, v30, v31
s_cbranch_vccnz L_S5_rg
v_mov_b32 v35, 0x3f80
ds_write_b16 v2, v24 offset:1184
ds_write_b16_d16_hi v2, v24 offset:5920
ds_write_b16 v2, v26 offset:2368
ds_write_b16_d16_hi v2, v26 offset:7104
ds_write_b16 v2, v35 offset:3552
ds_write_b16 v2, v35 offset:8288
s_waitcnt lgkmcnt(0)
s_barrier
global_load_dwordx2 v[24:25], v81, s[42:43] sc1
ds_read_b64_tr_b16 v[52:53], v92 offset:0
ds_read_b64_tr_b16 v[54:55], v92 offset:18432
ds_read_b64_tr_b16 v[56:57], v92 offset:36864
ds_read_b64_tr_b16 v[58:59], v92 offset:55296
ds_read_b64_tr_b16 v[60:61], v93 offset:0
ds_read_b64_tr_b16 v[62:63], v93 offset:18432
ds_read_b64_tr_b16 v[64:65], v93 offset:36864
ds_read_b64_tr_b16 v[66:67], v93 offset:55296
ds_read_b64_tr_b16 v[68:69], v94 offset:0
ds_read_b64_tr_b16 v[70:71], v94 offset:18432
ds_read_b64_tr_b16 v[72:73], v94 offset:36864
ds_read_b64_tr_b16 v[74:75], v94 offset:55296
s_branch L_S5_xac
L_S5_xa:
s_add_u32 s7, s7, 1
s_cmp_gt_u32 s7, 400000
s_cbranch_scc1 L_end
s_cmp_lg_u32 s7, 300
s_cbranch_scc1 L_S5_xa_k
v_add_u32 v81, 524288, v81
L_S5_xa_k:
global_load_dwordx2 v[24:25], v81, s[42:43] sc1
L_S5_xac:
s_waitcnt vmcnt(0)
v_cmp_ne_u32 vcc, s6, v25
s_cbranch_vccnz L_S5_xa
ds_write_b16 v2, v24
ds_write_b16_d16_hi v2, v24 offset:4736
s_waitcnt lgkmcnt(0)
s_barrier
s_branch L_S5_g2
L_S5_hi:
s_waitcnt vmcnt(4)
s_mov_b64 exec, 1
ds_add_u32 v21, v22 offset:4
s_mov_b64 exec, -1
s_cmp_ge_u32 s3, 12
s_cbranch_scc1 L_S5_g1
s_waitcnt vmcnt(0)
s_barrier
ds_read_b64_tr_b16 v[52:53], v92 offset:0
ds_read_b64_tr_b16 v[54:55], v92 offset:18432
ds_read_b64_tr_b16 v[56:57], v92 offset:36864
ds_read_b64_tr_b16 v[58:59], v92 offset:55296
ds_read_b64_tr_b16 v[60:61], v93 offset:0
ds_read_b64_tr_b16 v[62:63], v93 offset:18432
ds_read_b64_tr_b16 v[64:65], v93 offset:36864
ds_read_b64_tr_b16 v[66:67], v93 offset:55296
ds_read_b64_tr_b16 v[68:69], v94 offset:0
ds_read_b64_tr_b16 v[70:71], v94 offset:18432
ds_read_b64_tr_b16 v[72:73], v94 offset:36864
ds_read_b64_tr_b16 v[74:75], v94 offset:55296
s_cmp_lg_u32 s3, 10
s_cbranch_scc1 L_S5_h2
global_load_dwordx2 v[86:87], v83, s[42:43] sc1
s_barrier
s_mov_b32 s7, 0
s_branch L_S5_gb1
L_S5_gb:
s_add_u32 s7, s7, 1
s_cmp_gt_u32 s7, 400000
s_cbranch_scc1 L_end
s_cmp_lg_u32 s7, 300
s_cbranch_scc1 L_S5_gb_k
v_add_u32 v77, 524288, v77
L_S5_gb_k:
global_load_dwordx2 v[86:87], v83, s[42:43] sc1
L_S5_gb1:
global_load_dwordx2 v[90:91], v77, s[42:43] sc1
s_waitcnt vmcnt(0)
v_min3_u32 v30, v87, v91, s6
v_max3_u32 v31, v87, v91, s6
v_cmp_ne_u32 vcc, v30, v31
s_cbranch_vccnz L_S5_gb
v_lshrrev_b32 v86, v78, v86
v_lshrrev_b32 v85, v78, v90
v_lshlrev_b32 v86, 16, v86
v_lshlrev_b32 v85, 16, v85
v_lshlrev_b32 v84, 16, v84
s_branch L_S5_g2
L_S5_h2:
s_barrier
L_S5_g2:
s_mov_b32 s56, 0xffff0000
s_mov_b32 s57, 0
s_mov_b32 s58, 0
s_mov_b32 s59, 0xffff
v_bfe_i32 v36, v1, 0, 1
v_and_b32 v36, 0xaaaa, v36
v_or_b32 v36, 0x4444, v36
v_mov_b32 v40, 0
v_mov_b32 v41, 0
v_mov_b32 v42, 0
v_mov_b32 v43, 0
v_mov_b32 v44, 0
v_mov_b32 v45, 0
v_mov_b32 v46, 0
v_mov_b32 v47, 0
v_mov_b32 v48, 0
v_mov_b32 v49, 0
v_mov_b32 v50, 0
v_mov_b32 v51, 0
s_waitcnt lgkmcnt(0)
s_barrier
ds_read_b128 v[32:35], v79
s_waitcnt lgkmcnt(0)
v_smfmac_f32_16x16x64_bf16 v[40:43], v[32:35], v[52:59], v36
v_smfmac_f32_16x16x64_bf16 v[44:47], v[32:35], v[60:67], v36
v_smfmac_f32_16x16x64_bf16 v[48:51], v[32:35], v[68:75], v36
s_mov_b32 exec_hi, 0xffff
s_nop 5
v_cndmask_b32 v28, v40, v44, s[56:57]
v_cndmask_b32 v29, v41, v45, s[56:57]
v_cndmask_b32 v30, v42, v46, s[56:57]
v_cndmask_b32 v31, v43, v47, s[56:57]
v_cndmask_b32 v28, v28, v48, s[58:59]
v_cndmask_b32 v29, v29, v49, s[58:59]
v_cndmask_b32 v30, v30, v50, s[58:59]
v_cndmask_b32 v31, v31, v51, s[58:59]
v_add_f32 v28, v28, v29
v_add_f32 v29, v30, v31
v_bfi_b32 v28, 63, s101, v28
v_bfi_b32 v29, 63, s101, v29
global_store_dwordx2 v76, v[28:29], s[42:43] sc1
s_mov_b64 exec, -1
s_cmp_lg_u32 s3, 10
s_cbranch_scc1 L_end
s_sleep 13
s_mov_b32 s7, 0
L_S5_fg:
s_add_u32 s7, s7, 1
s_cmp_gt_u32 s7, 400000
s_cbranch_scc1 L_end
global_load_dwordx2 v[40:41], v88, s[42:43] offset:-2048 sc1
global_load_dwordx2 v[42:43], v88, s[42:43] offset:-1536 sc1
global_load_dwordx2 v[44:45], v88, s[42:43] offset:-1024 sc1
global_load_dwordx2 v[46:47], v88, s[42:43] offset:-512 sc1
global_load_dwordx2 v[48:49], v88, s[42:43] offset:0 sc1
global_load_dwordx2 v[50:51], v88, s[42:43] offset:512 sc1
global_load_dwordx2 v[52:53], v88, s[42:43] offset:1024 sc1
global_load_dwordx2 v[54:55], v88, s[42:43] offset:1536 sc1
global_load_dwordx2 v[56:57], v88, s[42:43] offset:2048 sc1
s_waitcnt vmcnt(8)
v_xor_b32 v40, s101, v40
v_xor_b32 v41, s101, v41
v_or_b32 v30, v40, v41
s_waitcnt vmcnt(7)
v_xor_b32 v42, s101, v42
v_xor_b32 v43, s101, v43
v_or3_b32 v30, v42, v43, v30
v_add_f32 v40, v40, v42
v_add_f32 v41, v41, v43
s_waitcnt vmcnt(6)
v_xor_b32 v44, s101, v44
v_xor_b32 v45, s101, v45
v_or3_b32 v30, v44, v45, v30
v_add_f32 v40, v40, v44
v_add_f32 v41, v41, v45
s_waitcnt vmcnt(5)
v_xor_b32 v46, s101, v46
v_xor_b32 v47, s101, v47
v_or3_b32 v30, v46, v47, v30
v_add_f32 v40, v40, v46
v_add_f32 v41, v41, v47
s_waitcnt vmcnt(4)
v_xor_b32 v48, s101, v48
v_xor_b32 v49, s101, v49
v_or3_b32 v30, v48, v49, v30
v_add_f32 v40, v40, v48
v_add_f32 v41, v41, v49
s_waitcnt vmcnt(3)
v_xor_b32 v50, s101, v50
v_xor_b32 v51, s101, v51
v_or3_b32 v30, v50, v51, v30
v_add_f32 v40, v40, v50
v_add_f32 v41, v41, v51
s_waitcnt vmcnt(2)
v_xor_b32 v52, s101, v52
v_xor_b32 v53, s101, v53
v_or3_b32 v30, v52, v53, v30
v_add_f32 v40, v40, v52
v_add_f32 v41, v41, v53
s_waitcnt vmcnt(1)
v_xor_b32 v54, s101, v54
v_xor_b32 v55, s101, v55
v_or3_b32 v30, v54, v55, v30
v_add_f32 v40, v40, v54
v_add_f32 v41, v41, v55
s_waitcnt vmcnt(0)
v_xor_b32 v56, s101, v56
v_xor_b32 v57, s101, v57
v_or3_b32 v30, v56, v57, v30
v_add_f32 v40, v40, v56
v_add_f32 v41, v41, v57
v_and_b32 v30, 63, v30
v_cmp_ne_u32 vcc, 0, v30
s_cbranch_vccnz L_S5_fg
v_permlane32_swap_b32 v40, v41
v_add_f32 v40, v40, v41
v_mov_b32 v42, v40
s_nop 1
v_permlane16_swap_b32 v40, v42
v_add_f32 v40, v40, v42
s_nop 1
v_add_f32_dpp v40, v40, v40 row_ror:8 row_mask:0xf bank_mask:0xf
v_cvt_pk_bf16_f32 v40, 0, v40
v_add_f32 v40, v84, v40
v_cvt_pk_bf16_f32 v40, 0, v40
v_mul_f32 v40, v86, v40
v_cvt_pk_bf16_f32 v40, 0, v40
v_add_f32 v40, v85, v40
v_cvt_pk_bf16_f32 v40, v40, v40
s_mov_b32 exec_lo, 0xff
s_mov_b32 exec_hi, 0xff
global_store_short v82, v40, s[40:41] sc1
s_cmp_lg_u32 s47, 0
s_cbranch_scc1 L_S5_fin
s_mov_b64 exec, 1
v_mov_b32 v33, s6
global_store_dword v3, v33, s[42:43] sc1
L_S5_fin:
s_mov_b64 exec, -1
s_branch L_end
L_S5_g1:
v_mov_b32 v15, v10
s_mov_b32 s7, 0
LS_22:
s_add_u32 s7, s7, 1
s_cmp_gt_u32 s7, 400000
s_cbranch_scc1 L_end
ds_read_b32 v16, v21 offset:4
s_waitcnt lgkmcnt(0)
v_readfirstlane_b32 s44, v16
s_cmp_ge_u32 s44, 16
s_cbranch_scc1 LD_23
s_sleep 1
s_branch LS_22
LD_23:
ds_read_b64_tr_b16 v[52:53], v15 offset:0
ds_read_b64_tr_b16 v[54:55], v15 offset:2048
ds_read_b64_tr_b16 v[56:57], v15 offset:4096
ds_read_b64_tr_b16 v[58:59], v15 offset:6144
ds_read_b64_tr_b16 v[60:61], v15 offset:8192
ds_read_b64_tr_b16 v[62:63], v15 offset:10240
ds_read_b64_tr_b16 v[64:65], v15 offset:12288
ds_read_b64_tr_b16 v[66:67], v15 offset:14336
ds_read_b64_tr_b16 v[68:69], v15 offset:16384
ds_read_b64_tr_b16 v[70:71], v15 offset:18432
ds_read_b64_tr_b16 v[72:73], v15 offset:20480
ds_read_b64_tr_b16 v[74:75], v15 offset:22528
ds_read_b64_tr_b16 v[76:77], v15 offset:24576
ds_read_b64_tr_b16 v[78:79], v15 offset:26624
ds_read_b64_tr_b16 v[80:81], v15 offset:28672
ds_read_b64_tr_b16 v[82:83], v15 offset:30720
ds_read_b64_tr_b16 v[84:85], v15 offset:32768
ds_read_b64_tr_b16 v[86:87], v15 offset:34816
ds_read_b64_tr_b16 v[88:89], v15 offset:36864
ds_read_b64_tr_b16 v[90:91], v15 offset:38912
ds_read_b64_tr_b16 v[92:93], v15 offset:40960
ds_read_b64_tr_b16 v[94:95], v15 offset:43008
ds_read_b64_tr_b16 v[96:97], v15 offset:45056
ds_read_b64_tr_b16 v[98:99], v15 offset:47104
ds_read_b64_tr_b16 v[100:101], v15 offset:49152
ds_read_b64_tr_b16 v[102:103], v15 offset:51200
ds_read_b64_tr_b16 v[104:105], v15 offset:53248
ds_read_b64_tr_b16 v[106:107], v15 offset:55296
ds_read_b64_tr_b16 v[108:109], v15 offset:57344
ds_read_b64_tr_b16 v[110:111], v15 offset:59392
ds_read_b64_tr_b16 v[112:113], v15 offset:61440
ds_read_b64_tr_b16 v[114:115], v15 offset:63488
v_add_u32 v15, 65536, v15
ds_read_b64_tr_b16 v[116:117], v15 offset:0
ds_read_b64_tr_b16 v[118:119], v15 offset:2048
ds_read_b64_tr_b16 v[120:121], v15 offset:4096
ds_read_b64_tr_b16 v[122:123], v15 offset:6144
v_lshrrev_b32 v16, 4, v1
s_lshl_b32 s44, s4, 7
s_add_u32 s44, s44, 1380352
v_lshl_add_u32 v18, v16, 3, s44
v_lshrrev_b32 v15, 5, v1
v_lshlrev_b32 v15, 7, v15
v_and_b32 v16, 13, v1
v_lshl_or_b32 v15, v16, 1, v15
v_bfe_u32 v16, v1, 1, 1
v_lshl_or_b32 v15, v16, 6, v15
s_lshr_b32 s44, s46, 1
s_lshl_b32 s44, s44, 5
s_and_b32 s45, s46, 1
s_lshl_b32 s45, s45, 2
s_add_u32 s44, s44, s45
s_add_u32 s44, s44, 156928
v_add_u32 v15, s44, v15
v_lshlrev_b32 v19, 16, v19
v_bfe_u32 v16, v1, 1, 3
v_mul_u32_u24 v16, 1184, v16
v_add_u32 v16, v11, v16
v_mov_b32 v17, 0xc0135761
v_bfe_i32 v14, v1, 0, 1
v_and_b32 v14, 0xaaaa, v14
v_or_b32 v14, 0x4444, v14
v_mov_b32 v20, 0
v_mov_b32 v21, 0
v_mov_b32 v22, 0
v_mov_b32 v23, 0
v_and_b32 v18, 15, v1
v_min_u32 v18, 8, v18
v_and_b32 v24, 48, v1
v_add_u32 v18, v18, v24
s_lshl_b32 s44, s4, 11
s_add_u32 s44, s44, 1343488
v_lshl_add_u32 v18, v18, 4, s44
s_mov_b32 s56, 0x01ff01ff
s_mov_b32 s57, 0x01ff01ff
s_mov_b32 s58, 0xffff0000
s_mov_b32 s59, 0xffff0000
global_load_dword v24, v18, s[42:43] offset:1024 sc1
global_load_dwordx3 v[124:126], v18, s[42:43] sc1
s_waitcnt vmcnt(0) lgkmcnt(0)
s_barrier
s_mov_b32 s7, 0
s_branch L_S5_s0c
L_S5_s0:
s_add_u32 s7, s7, 1
s_cmp_gt_u32 s7, 400000
s_cbranch_scc1 L_end
s_cmp_lg_u32 s7, 300
s_cbranch_scc1 L_S5_s0_k
v_add_u32 v18, 524288, v18
L_S5_s0_k:
global_load_dwordx3 v[124:126], v18, s[42:43] sc1
s_waitcnt vmcnt(0)
L_S5_s0c:
v_xor_b32 v124, s101, v124
v_xor_b32 v125, s101, v125
v_xor_b32 v126, s101, v126
v_or3_b32 v30, v124, v125, v126
v_and_b32 v30, 63, v30
v_cmp_ne_u32 vcc, 0, v30
s_cbranch_vccnz L_S5_s0
v_cndmask_b32 v124, 0, v124, s[56:57]
v_cndmask_b32 v125, 0, v125, s[56:57]
v_cndmask_b32 v126, 0, v126, s[56:57]
v_add_f32_dpp v124, v124, v124 quad_perm:[1,0,3,2] row_mask:0xf bank_mask:0xf
v_add_f32_dpp v125, v125, v125 quad_perm:[1,0,3,2] row_mask:0xf bank_mask:0xf
v_add_f32_dpp v126, v126, v126 quad_perm:[1,0,3,2] row_mask:0xf bank_mask:0xf
v_add_f32_dpp v124, v124, v124 quad_perm:[2,3,0,1] row_mask:0xf bank_mask:0xf
v_add_f32_dpp v125, v125, v125 quad_perm:[2,3,0,1] row_mask:0xf bank_mask:0xf
v_add_f32_dpp v126, v126, v126 quad_perm:[2,3,0,1] row_mask:0xf bank_mask:0xf
v_add_f32_dpp v124, v124, v124 row_half_mirror row_mask:0xf bank_mask:0xf
v_add_f32_dpp v125, v125, v125 row_half_mirror row_mask:0xf bank_mask:0xf
v_add_f32_dpp v126, v126, v126 row_half_mirror row_mask:0xf bank_mask:0xf
v_add_f32_dpp v124, v124, v124 row_mirror row_mask:0xf bank_mask:0xf
v_add_f32_dpp v125, v125, v125 row_mirror row_mask:0xf bank_mask:0xf
v_add_f32_dpp v126, v126, v126 row_mirror row_mask:0xf bank_mask:0xf
v_mul_f32 v3, 0x3ae38e39, v124
v_mul_f32 v13, 0x3ae38e39, v125
v_mul_f32 v5, 0x3b638e39, v126
v_mul_f32 v2, 0x3ae38e39, v124
v_mul_f32 v12, 0x3ae38e39, v125
v_mul_f32 v8, 0x3b638e39, v126
v_permlane16_swap_b32 v2, v3
v_permlane16_swap_b32 v12, v13
v_permlane16_swap_b32 v8, v5
L_S5_cf:
s_add_u32 s7, s7, 1
s_cmp_gt_u32 s7, 400000
s_cbranch_scc1 L_end
s_cmp_lg_u32 s7, 300
s_cbranch_scc1 L_S5_cf_k
v_add_u32 v18, 524288, v18
L_S5_cf_k:
global_load_dwordx3 v[124:126], v18, s[42:43] offset:1024 sc1
s_waitcnt vmcnt(0)
v_xor_b32 v124, s101, v124
v_xor_b32 v125, s101, v125
v_xor_b32 v126, s101, v126
v_or3_b32 v30, v124, v125, v126
v_and_b32 v30, 63, v30
v_cmp_ne_u32 vcc, 0, v30
s_cbranch_vccnz L_S5_cf
s_barrier
ds_read_b128 v[24:27], v16 offset:0
ds_read_b128 v[28:31], v16 offset:128
ds_read_b128 v[32:35], v16 offset:256
ds_read_b128 v[36:39], v16 offset:384
ds_read_b128 v[40:43], v16 offset:512
v_cndmask_b32 v124, 0, v124, s[56:57]
v_cndmask_b32 v125, 0, v125, s[56:57]
v_cndmask_b32 v126, 0, v126, s[56:57]
v_add_f32_dpp v124, v124, v124 quad_perm:[1,0,3,2] row_mask:0xf bank_mask:0xf
v_add_f32_dpp v125, v125, v125 quad_perm:[1,0,3,2] row_mask:0xf bank_mask:0xf
v_add_f32_dpp v126, v126, v126 quad_perm:[1,0,3,2] row_mask:0xf bank_mask:0xf
v_add_f32_dpp v124, v124, v124 quad_perm:[2,3,0,1] row_mask:0xf bank_mask:0xf
v_add_f32_dpp v125, v125, v125 quad_perm:[2,3,0,1] row_mask:0xf bank_mask:0xf
v_add_f32_dpp v126, v126, v126 quad_perm:[2,3,0,1] row_mask:0xf bank_mask:0xf
v_add_f32_dpp v124, v124, v124 row_half_mirror row_mask:0xf bank_mask:0xf
v_add_f32_dpp v125, v125, v125 row_half_mirror row_mask:0xf bank_mask:0xf
v_add_f32_dpp v126, v126, v126 row_half_mirror row_mask:0xf bank_mask:0xf
v_add_f32_dpp v124, v124, v124 row_mirror row_mask:0xf bank_mask:0xf
v_add_f32_dpp v125, v125, v125 row_mirror row_mask:0xf bank_mask:0xf
v_add_f32_dpp v126, v126, v126 row_mirror row_mask:0xf bank_mask:0xf
s_waitcnt lgkmcnt(4)
v_smfmac_f32_16x16x64_bf16 v[20:23], v[24:27], v[52:59], v14
ds_read_b128 v[24:27], v16 offset:640
v_mul_f32 v45, 0x3ae38e39, v124
v_mul_f32 v47, 0x3ae38e39, v125
v_mul_f32 v49, 0xbb638e39, v126
s_waitcnt lgkmcnt(4)
v_smfmac_f32_16x16x64_bf16 v[20:23], v[28:31], v[60:67], v14
ds_read_b128 v[28:31], v16 offset:768
v_mul_f32 v44, 0x3ae38e39, v124
v_mul_f32 v46, 0x3ae38e39, v125
v_mul_f32 v48, 0xbb638e39, v126
s_waitcnt lgkmcnt(4)
v_smfmac_f32_16x16x64_bf16 v[20:23], v[32:35], v[68:75], v14
ds_read_b128 v[32:35], v16 offset:896
v_permlane16_swap_b32 v44, v45
v_permlane16_swap_b32 v46, v47
v_permlane16_swap_b32 v48, v49
s_waitcnt lgkmcnt(4)
v_smfmac_f32_16x16x64_bf16 v[20:23], v[36:39], v[76:83], v14
ds_read_b128 v[36:39], v16 offset:1024
v_fma_f32 v45, -v44, v44, v45
v_max_f32 v45, 0, v45
v_cvt_pk_bf16_f32 v45, 0, v45
s_waitcnt lgkmcnt(4)
v_smfmac_f32_16x16x64_bf16 v[20:23], v[40:43], v[84:91], v14
v_add_f32 v45, 0x3727c5ac, v45
v_cvt_pk_bf16_f32 v45, 0, v45
v_sqrt_f32 v45, v45
s_waitcnt lgkmcnt(3)
v_smfmac_f32_16x16x64_bf16 v[20:23], v[24:27], v[92:99], v14
v_cvt_pk_bf16_f32 v44, 0, v44
v_cvt_pk_bf16_f32 v45, 0, v45
v_rcp_f32 v50, v45
s_waitcnt lgkmcnt(2)
v_smfmac_f32_16x16x64_bf16 v[20:23], v[28:31], v[100:107], v14
v_fma_f32 v48, v44, v3, v48
v_fma_f32 v46, -v44, v2, v46
v_fma_f32 v49, v44, v8, v49
s_waitcnt lgkmcnt(1)
v_smfmac_f32_16x16x64_bf16 v[20:23], v[32:35], v[108:115], v14
v_fma_f32 v47, v44, v48, v47
v_fma_f32 v46, v50, v46, v12
v_fma_f32 v47, v50, v47, -v49
s_waitcnt lgkmcnt(0)
v_smfmac_f32_16x16x64_bf16 v[20:23], v[36:39], v[116:123], v14
v_fma_f32 v47, v50, v47, v13
v_fma_f32 v47, -v46, v46, v47
v_max_f32 v47, 0, v47
v_cvt_pk_bf16_f32 v47, 0, v47
v_add_f32 v47, 0x3727c5ac, v47
v_cvt_pk_bf16_f32 v47, 0, v47
v_sqrt_f32 v47, v47
v_cvt_pk_bf16_f32 v46, 0, v46
v_cvt_pk_bf16_f32 v47, 0, v47
v_rcp_f32 v51, v47
v_mul_f32 v44, v44, v50
v_cndmask_b32 v124, v50, 1.0, s[58:59]
v_cndmask_b32 v125, v44, v46, s[58:59]
v_add_f32 v20, v20, v21
v_add_f32 v22, v22, v23
v_mul_f32 v124, v124, v51
v_mul_f32 v125, -v125, v51
v_mul_f32 v20, v20, v124
v_fmac_f32 v20, v22, v125
v_mov_b32 v21, v20
s_nop 1
v_permlane16_swap_b32 v20, v21
v_add_f32 v20, v20, v21
v_cvt_pk_bf16_f32 v20, 0, v20
v_add_f32 v20, v20, v19
v_cvt_pk_bf16_f32 v20, 0, v20
v_mul_f32 v21, v20, v20
v_fmamk_f32 v21, v21, 0xbdd2d3e8, v17
v_mul_f32 v21, v21, v20
v_exp_f32 v21, v21
s_nop 0
v_add_f32 v21, 1.0, v21
v_rcp_f32 v21, v21
s_mov_b32 exec_lo, 0xffff
s_mov_b32 exec_hi, 0xffff
v_mul_f32 v21, v21, v20
v_cvt_pk_bf16_f32 v21, v21, v21
ds_write_b16 v15, v21
s_mov_b64 exec, -1
s_waitcnt lgkmcnt(0)
s_barrier
L_end:
L_exit:
s_endpgm
L_codeend:
.section .rodata,"a"
.p2align 6
.amdhsa_kernel adaLN_cond__sliding_block_cached__mixer_channel_mlp__decode_kernel
.amdhsa_next_free_vgpr 128
.amdhsa_next_free_sgpr 102
.amdhsa_accum_offset 128
.amdhsa_group_segment_fixed_size 0
.amdhsa_kernarg_size 120
.amdhsa_user_sgpr_count 2
.amdhsa_user_sgpr_kernarg_segment_ptr 1
.amdhsa_system_sgpr_workgroup_id_x 1
.end_amdhsa_kernel
```
